```python
import torch

def _softmax(x, axis=-1):
    return torch.softmax(x, dim=axis)
def _gelu(x):
    return torch.nn.functional.gelu(x, approximate="tanh")
def _silu(x):
    return torch.nn.functional.silu(x)
def _sigmoid(x):
    return torch.sigmoid(x)
def _layernorm(x, axis=-1, eps=1e-5):
    m = x.mean(dim=axis, keepdim=True)
    v = x.var(dim=axis, keepdim=True, unbiased=False)
    return (x - m) / torch.sqrt(v + eps)
def _scatter_add(tgt, idx, src, axis=0):
    return tgt.clone().index_add_(axis, idx, src)
def _segment_sum(src, seg, n):
    out = torch.zeros((n,) + src.shape[1:], dtype=src.dtype)
    return out.index_add_(0, seg, src)
def _pad(x, pw):
    flat = tuple(v for pair in reversed(pw) for v in pair)
    return torch.nn.functional.pad(x, flat)

kernel_name = 'standalone__sliding_window_attn__prompt'

def setup_inputs():

    _w = (lambda a: (lambda t: t.to(torch.bfloat16) if t.is_floating_point() else t)(torch.as_tensor(a)))
    B, H, S, D = 1, 16, 2048, 256
    return {
        "q": _w((lambda *s: torch.randn(*s, dtype=torch.bfloat16) * 0.8)(B, H, S, D)),
        "k": _w((lambda *s: torch.randn(*s, dtype=torch.bfloat16) * 0.8)(B, H, S, D)),
        "v": _w((lambda *s: torch.randn(*s, dtype=torch.bfloat16) * 0.05)(B, H, S, D)),
        "window": 256,
    }

def reference(q, k, v, window):
    B, H, S, D = q.shape
    scale = D ** -0.5
    scores = torch.einsum("bhqd,bhkd->bhqk", q, k) * scale
    idx = torch.arange(S)
    mask = (idx[:, None] - idx[None, :] >= 0) & (idx[:, None] - idx[None, :] < window)
    scores = torch.where(mask[None, None], scores, -1e9)
    p = _softmax(scores, axis=-1)
    return torch.einsum("bhqk,bhkd->bhqd", p, v)
```

```asm
; @launch grid=(256,1,1) block=(512,1,1) lds=163840
.amdgcn_target "amdgcn-amd-amdhsa--gfx950"
.text
.globl standalone__sliding_window_attn__prompt_kernel
.p2align 8
.type standalone__sliding_window_attn__prompt_kernel,@function
standalone__sliding_window_attn__prompt_kernel:
    s_cmp_ge_u32 s2, 256
    s_cbranch_scc1 L_end
    s_load_dwordx4 s[4:7], s[0:1], 0
    s_load_dwordx2 s[8:9], s[0:1], 16
    s_load_dwordx2 s[10:11], s[0:1], 32
    v_lshrrev_b32 v1, 6, v0
    v_and_b32 v0, 63, v0
    v_readfirstlane_b32 s62, v1
    s_and_b32 s31, s2, 7
    s_lshr_b32 s52, s2, 3
    s_lshr_b32 s53, s52, 4
    s_lshl_b32 s30, s31, 1
    s_add_u32 s30, s30, s53
    s_and_b32 s29, s52, 15
    s_add_u32 s31, s30, 0
    s_and_b32 s31, s31, 3
    s_lshl_b32 s48, s31, 7
    s_add_u32 s31, s30, 1
    s_and_b32 s31, s31, 3
    s_lshl_b32 s49, s31, 7
    s_add_u32 s31, s30, 2
    s_and_b32 s31, s31, 3
    s_lshl_b32 s50, s31, 7
    s_add_u32 s31, s30, 3
    s_and_b32 s31, s31, 3
    s_lshl_b32 s51, s31, 7
    s_and_b32 s28, s62, 3
    s_cmp_lt_u32 s62, 4
    s_cbranch_scc1 L_compute
L_loader:
    s_setprio 3
    s_getpc_b64 s[66:67]
L_pc:
    s_sub_u32 s66, s66, L_pc-standalone__sliding_window_attn__prompt_kernel
    s_subb_u32 s67, s67, 0
    s_lshr_b32 s31, s2, 3
    s_lshl_b32 s31, s31, 2
    s_add_u32 s31, s31, s28
    s_lshl_b32 s31, s31, 8
    v_and_b32 v8, 1, v0
    v_lshlrev_b32 v8, 7, v8
    v_add_u32 v8, s31, v8
    v_min_u32 v8, L_codeend-standalone__sliding_window_attn__prompt_kernel-4, v8
    global_load_dword v9, v8, s[66:67]
    v_lshrrev_b32 v5, 3, v0
    v_lshlrev_b32 v5, 9, v5
    v_and_b32 v6, 7, v0
    v_lshrrev_b32 v7, 4, v0
    v_xor_b32 v4, v6, v7
    v_lshl_add_u32 v1, v4, 4, v5
    v_xor_b32 v4, 4, v4
    v_lshl_add_u32 v2, v4, 4, v5
    v_and_b32 v7, 1, v7
    v_lshlrev_b32 v7, 2, v7
    v_xor_b32 v4, v6, v7
    v_lshl_add_u32 v3, v4, 4, v5
    s_lshl_b32 s44, s28, 13
    s_lshl_b32 s45, s28, 12
    s_lshl_b32 s31, s29, 7
    s_lshl_b32 s52, s28, 5
    s_add_u32 s52, s52, s31
    s_lshl_b32 s52, s52, 9
    s_add_u32 s40, s52, 0
    s_add_u32 s41, s52, 4096
    s_add_u32 s42, s52, 8192
    s_add_u32 s43, s52, 12288
    s_lshl_b32 s52, s28, 6
    s_add_u32 s52, s52, s31
    s_sub_u32 s52, s52, 256
    s_lshl_b32 s52, s52, 9
    s_add_i32 s53, s52, 0
    s_max_i32 s32, s53, 0
    s_add_i32 s53, s52, 4096
    s_max_i32 s33, s53, 0
    s_add_i32 s53, s52, 8192
    s_max_i32 s34, s53, 0
    s_add_i32 s53, s52, 12288
    s_max_i32 s35, s53, 0
    s_add_i32 s53, s52, 16384
    s_max_i32 s36, s53, 0
    s_add_i32 s53, s52, 20480
    s_max_i32 s37, s53, 0
    s_add_i32 s53, s52, 24576
    s_max_i32 s38, s53, 0
    s_add_i32 s53, s52, 28672
    s_max_i32 s39, s53, 0
    s_waitcnt lgkmcnt(0)
    s_lshl_b32 s31, s30, 20
    s_add_u32 s12, s4, s31
    s_addc_u32 s13, s5, 0
    s_mov_b32 s14, 1048576
    s_mov_b32 s15, 131072
    s_add_u32 s16, s6, s31
    s_addc_u32 s17, s7, 0
    s_mov_b32 s18, 1048576
    s_mov_b32 s19, 131072
    s_add_u32 s20, s8, s31
    s_addc_u32 s21, s9, 0
    s_mov_b32 s22, 1048576
    s_mov_b32 s23, 131072
    s_add_u32 m0, s45, 81920
    s_add_u32 s31, s40, s48
    buffer_load_dwordx4 v1, s[12:15], s31 offen nt lds
    s_add_u32 m0, s45, 82944
    s_add_u32 s31, s41, s48
    buffer_load_dwordx4 v2, s[12:15], s31 offen nt lds
    s_add_u32 m0, s45, 83968
    s_add_u32 s31, s42, s48
    buffer_load_dwordx4 v1, s[12:15], s31 offen nt lds
    s_add_u32 m0, s45, 84992
    s_add_u32 s31, s43, s48
    buffer_load_dwordx4 v2, s[12:15], s31 offen nt lds
    s_add_u32 m0, s45, 65536
    s_add_u32 s31, s40, s48
    buffer_load_dwordx4 v1, s[16:19], s31 offen lds
    s_add_u32 m0, s45, 66560
    s_add_u32 s31, s41, s48
    buffer_load_dwordx4 v2, s[16:19], s31 offen lds
    s_add_u32 m0, s45, 67584
    s_add_u32 s31, s42, s48
    buffer_load_dwordx4 v1, s[16:19], s31 offen lds
    s_add_u32 m0, s45, 68608
    s_add_u32 s31, s43, s48
    buffer_load_dwordx4 v2, s[16:19], s31 offen lds
    s_add_u32 m0, s44, 0
    s_add_u32 s31, s32, s48
    buffer_load_dwordx4 v1, s[16:19], s31 offen lds
    s_add_u32 m0, s44, 1024
    s_add_u32 s31, s33, s48
    buffer_load_dwordx4 v2, s[16:19], s31 offen lds
    s_add_u32 m0, s44, 2048
    s_add_u32 s31, s34, s48
    buffer_load_dwordx4 v1, s[16:19], s31 offen lds
    s_add_u32 m0, s44, 3072
    s_add_u32 s31, s35, s48
    buffer_load_dwordx4 v2, s[16:19], s31 offen lds
    s_add_u32 m0, s44, 4096
    s_add_u32 s31, s36, s48
    buffer_load_dwordx4 v1, s[16:19], s31 offen lds
    s_add_u32 m0, s44, 5120
    s_add_u32 s31, s37, s48
    buffer_load_dwordx4 v2, s[16:19], s31 offen lds
    s_add_u32 m0, s44, 6144
    s_add_u32 s31, s38, s48
    buffer_load_dwordx4 v1, s[16:19], s31 offen lds
    s_add_u32 m0, s44, 7168
    s_add_u32 s31, s39, s48
    buffer_load_dwordx4 v2, s[16:19], s31 offen lds
    s_add_u32 m0, s45, 114688
    s_add_u32 s31, s40, s49
    buffer_load_dwordx4 v1, s[12:15], s31 offen nt lds
    s_add_u32 m0, s45, 115712
    s_add_u32 s31, s41, s49
    buffer_load_dwordx4 v2, s[12:15], s31 offen nt lds
    s_add_u32 m0, s45, 116736
    s_add_u32 s31, s42, s49
    buffer_load_dwordx4 v1, s[12:15], s31 offen nt lds
    s_add_u32 m0, s45, 117760
    s_add_u32 s31, s43, s49
    buffer_load_dwordx4 v2, s[12:15], s31 offen nt lds
    s_add_u32 m0, s45, 98304
    s_add_u32 s31, s40, s49
    buffer_load_dwordx4 v1, s[16:19], s31 offen lds
    s_add_u32 m0, s45, 99328
    s_add_u32 s31, s41, s49
    buffer_load_dwordx4 v2, s[16:19], s31 offen lds
    s_add_u32 m0, s45, 100352
    s_add_u32 s31, s42, s49
    buffer_load_dwordx4 v1, s[16:19], s31 offen lds
    s_add_u32 m0, s45, 101376
    s_add_u32 s31, s43, s49
    buffer_load_dwordx4 v2, s[16:19], s31 offen lds
L_pad0:
    s_cbranch_execz L_pad1
    s_waitcnt vmcnt(8)
    s_barrier
    s_add_u32 m0, s44, 32768
    s_add_u32 s31, s32, s49
    buffer_load_dwordx4 v1, s[16:19], s31 offen lds
    s_add_u32 m0, s44, 33792
    s_add_u32 s31, s33, s49
    buffer_load_dwordx4 v2, s[16:19], s31 offen lds
    s_add_u32 m0, s44, 34816
    s_add_u32 s31, s34, s49
    buffer_load_dwordx4 v1, s[16:19], s31 offen lds
    s_add_u32 m0, s44, 35840
    s_add_u32 s31, s35, s49
    buffer_load_dwordx4 v2, s[16:19], s31 offen lds
    s_add_u32 m0, s44, 36864
    s_add_u32 s31, s36, s49
    buffer_load_dwordx4 v1, s[16:19], s31 offen lds
    s_add_u32 m0, s44, 37888
    s_add_u32 s31, s37, s49
    buffer_load_dwordx4 v2, s[16:19], s31 offen lds
    s_add_u32 m0, s44, 38912
    s_add_u32 s31, s38, s49
    buffer_load_dwordx4 v1, s[16:19], s31 offen lds
    s_add_u32 m0, s44, 39936
    s_add_u32 s31, s39, s49
    buffer_load_dwordx4 v2, s[16:19], s31 offen lds
    s_add_u32 m0, s45, 147456
    s_add_u32 s31, s40, s50
    buffer_load_dwordx4 v1, s[12:15], s31 offen nt lds
    s_add_u32 m0, s45, 148480
    s_add_u32 s31, s41, s50
    buffer_load_dwordx4 v2, s[12:15], s31 offen nt lds
    s_add_u32 m0, s45, 149504
    s_add_u32 s31, s42, s50
    buffer_load_dwordx4 v1, s[12:15], s31 offen nt lds
    s_add_u32 m0, s45, 150528
    s_add_u32 s31, s43, s50
    buffer_load_dwordx4 v2, s[12:15], s31 offen nt lds
    s_add_u32 m0, s45, 131072
L_pad1:
    s_cbranch_execz L_pad2
    s_add_u32 s31, s40, s50
    buffer_load_dwordx4 v1, s[16:19], s31 offen lds
    s_add_u32 m0, s45, 132096
    s_add_u32 s31, s41, s50
    buffer_load_dwordx4 v2, s[16:19], s31 offen lds
    s_add_u32 m0, s45, 133120
    s_add_u32 s31, s42, s50
    buffer_load_dwordx4 v1, s[16:19], s31 offen lds
    s_add_u32 m0, s45, 134144
    s_add_u32 s31, s43, s50
    buffer_load_dwordx4 v2, s[16:19], s31 offen lds
    s_waitcnt vmcnt(8)
    s_barrier
    s_add_u32 m0, s44, 0
    s_add_u32 s31, s32, s50
    buffer_load_dwordx4 v1, s[16:19], s31 offen lds
    s_add_u32 m0, s44, 1024
    s_add_u32 s31, s33, s50
    buffer_load_dwordx4 v2, s[16:19], s31 offen lds
    s_add_u32 m0, s44, 2048
    s_add_u32 s31, s34, s50
    buffer_load_dwordx4 v1, s[16:19], s31 offen lds
    s_add_u32 m0, s44, 3072
    s_add_u32 s31, s35, s50
    buffer_load_dwordx4 v2, s[16:19], s31 offen lds
    s_add_u32 m0, s44, 4096
    s_add_u32 s31, s36, s50
    buffer_load_dwordx4 v1, s[16:19], s31 offen lds
    s_add_u32 m0, s44, 5120
    s_add_u32 s31, s37, s50
    buffer_load_dwordx4 v2, s[16:19], s31 offen lds
    s_add_u32 m0, s44, 6144
    s_add_u32 s31, s38, s50
    buffer_load_dwordx4 v1, s[16:19], s31 offen lds
    s_add_u32 m0, s44, 7168
    s_add_u32 s31, s39, s50
    buffer_load_dwordx4 v2, s[16:19], s31 offen lds
    s_add_u32 m0, s45, 81920
    s_add_u32 s31, s40, s51
    buffer_load_dwordx4 v1, s[12:15], s31 offen nt lds
L_pad2:
    s_cbranch_execz L_pad3
    s_add_u32 m0, s45, 82944
    s_add_u32 s31, s41, s51
    buffer_load_dwordx4 v2, s[12:15], s31 offen nt lds
    s_add_u32 m0, s45, 83968
    s_add_u32 s31, s42, s51
    buffer_load_dwordx4 v1, s[12:15], s31 offen nt lds
    s_add_u32 m0, s45, 84992
    s_add_u32 s31, s43, s51
    buffer_load_dwordx4 v2, s[12:15], s31 offen nt lds
    s_add_u32 m0, s45, 65536
    s_add_u32 s31, s40, s51
    buffer_load_dwordx4 v1, s[16:19], s31 offen lds
    s_add_u32 m0, s45, 66560
    s_add_u32 s31, s41, s51
    buffer_load_dwordx4 v2, s[16:19], s31 offen lds
    s_add_u32 m0, s45, 67584
    s_add_u32 s31, s42, s51
    buffer_load_dwordx4 v1, s[16:19], s31 offen lds
    s_add_u32 m0, s45, 68608
    s_add_u32 s31, s43, s51
    buffer_load_dwordx4 v2, s[16:19], s31 offen lds
    s_waitcnt vmcnt(8)
    s_barrier
    s_add_u32 m0, s44, 32768
    s_add_u32 s31, s32, s51
    buffer_load_dwordx4 v1, s[16:19], s31 offen lds
    s_add_u32 m0, s44, 33792
    s_add_u32 s31, s33, s51
    buffer_load_dwordx4 v2, s[16:19], s31 offen lds
    s_add_u32 m0, s44, 34816
    s_add_u32 s31, s34, s51
    buffer_load_dwordx4 v1, s[16:19], s31 offen lds
    s_add_u32 m0, s44, 35840
    s_add_u32 s31, s35, s51
    buffer_load_dwordx4 v2, s[16:19], s31 offen lds
    s_add_u32 m0, s44, 36864
    s_add_u32 s31, s36, s51
    buffer_load_dwordx4 v1, s[16:19], s31 offen lds
    s_add_u32 m0, s44, 37888
L_pad3:
    s_cbranch_execz L_pad4
    s_add_u32 s31, s37, s51
    buffer_load_dwordx4 v2, s[16:19], s31 offen lds
    s_add_u32 m0, s44, 38912
    s_add_u32 s31, s38, s51
    buffer_load_dwordx4 v1, s[16:19], s31 offen lds
    s_add_u32 m0, s44, 39936
    s_add_u32 s31, s39, s51
    buffer_load_dwordx4 v2, s[16:19], s31 offen lds
    s_add_u32 m0, s45, 98304
    s_add_u32 s31, s40, s48
    buffer_load_dwordx4 v3, s[20:23], s31 offen lds
    s_add_u32 m0, s45, 99328
    s_add_u32 s31, s41, s48
    buffer_load_dwordx4 v3, s[20:23], s31 offen lds
    s_add_u32 m0, s45, 100352
    s_add_u32 s31, s42, s48
    buffer_load_dwordx4 v3, s[20:23], s31 offen lds
    s_add_u32 m0, s45, 101376
    s_add_u32 s31, s43, s48
    buffer_load_dwordx4 v3, s[20:23], s31 offen lds
    s_waitcnt vmcnt(4)
    s_barrier
    s_add_u32 m0, s44, 0
    s_add_u32 s31, s32, s48
    buffer_load_dwordx4 v3, s[20:23], s31 offen lds
    s_add_u32 m0, s44, 1024
    s_add_u32 s31, s33, s48
    buffer_load_dwordx4 v3, s[20:23], s31 offen lds
    s_add_u32 m0, s44, 2048
    s_add_u32 s31, s34, s48
    buffer_load_dwordx4 v3, s[20:23], s31 offen lds
    s_add_u32 m0, s44, 3072
    s_add_u32 s31, s35, s48
    buffer_load_dwordx4 v3, s[20:23], s31 offen lds
    s_add_u32 m0, s44, 4096
    s_add_u32 s31, s36, s48
    buffer_load_dwordx4 v3, s[20:23], s31 offen lds
    s_add_u32 m0, s44, 5120
    s_add_u32 s31, s37, s48
    buffer_load_dwordx4 v3, s[20:23], s31 offen lds
L_pad4:
    s_cbranch_execz L_pad5
    s_add_u32 m0, s44, 6144
    s_add_u32 s31, s38, s48
    buffer_load_dwordx4 v3, s[20:23], s31 offen lds
    s_add_u32 m0, s44, 7168
    s_add_u32 s31, s39, s48
    buffer_load_dwordx4 v3, s[20:23], s31 offen lds
    s_add_u32 m0, s45, 114688
    s_add_u32 s31, s40, s49
    buffer_load_dwordx4 v3, s[20:23], s31 offen lds
    s_add_u32 m0, s45, 115712
    s_add_u32 s31, s41, s49
    buffer_load_dwordx4 v3, s[20:23], s31 offen lds
    s_add_u32 m0, s45, 116736
    s_add_u32 s31, s42, s49
    buffer_load_dwordx4 v3, s[20:23], s31 offen lds
    s_add_u32 m0, s45, 117760
    s_add_u32 s31, s43, s49
    buffer_load_dwordx4 v3, s[20:23], s31 offen lds
    s_add_u32 m0, s45, 131072
    s_add_u32 s31, s40, s50
    buffer_load_dwordx4 v3, s[20:23], s31 offen lds
    s_add_u32 m0, s45, 132096
    s_add_u32 s31, s41, s50
    buffer_load_dwordx4 v3, s[20:23], s31 offen lds
    s_add_u32 m0, s45, 133120
    s_add_u32 s31, s42, s50
    buffer_load_dwordx4 v3, s[20:23], s31 offen lds
    s_add_u32 m0, s45, 134144
    s_add_u32 s31, s43, s50
    buffer_load_dwordx4 v3, s[20:23], s31 offen lds
    s_waitcnt vmcnt(8)
    s_barrier
    s_add_u32 m0, s44, 32768
    s_add_u32 s31, s32, s49
    buffer_load_dwordx4 v3, s[20:23], s31 offen lds
    s_add_u32 m0, s44, 33792
    s_add_u32 s31, s33, s49
    buffer_load_dwordx4 v3, s[20:23], s31 offen lds
    s_add_u32 m0, s44, 34816
L_pad5:
    s_cbranch_execz L_pad6
    s_add_u32 s31, s34, s49
    buffer_load_dwordx4 v3, s[20:23], s31 offen lds
    s_add_u32 m0, s44, 35840
    s_add_u32 s31, s35, s49
    buffer_load_dwordx4 v3, s[20:23], s31 offen lds
    s_add_u32 m0, s44, 36864
    s_add_u32 s31, s36, s49
    buffer_load_dwordx4 v3, s[20:23], s31 offen lds
    s_add_u32 m0, s44, 37888
    s_add_u32 s31, s37, s49
    buffer_load_dwordx4 v3, s[20:23], s31 offen lds
    s_add_u32 m0, s44, 38912
    s_add_u32 s31, s38, s49
    buffer_load_dwordx4 v3, s[20:23], s31 offen lds
    s_add_u32 m0, s44, 39936
    s_add_u32 s31, s39, s49
    buffer_load_dwordx4 v3, s[20:23], s31 offen lds
    s_add_u32 m0, s45, 147456
    s_add_u32 s31, s40, s51
    buffer_load_dwordx4 v3, s[20:23], s31 offen lds
    s_add_u32 m0, s45, 148480
    s_add_u32 s31, s41, s51
    buffer_load_dwordx4 v3, s[20:23], s31 offen lds
    s_add_u32 m0, s45, 149504
    s_add_u32 s31, s42, s51
    buffer_load_dwordx4 v3, s[20:23], s31 offen lds
    s_add_u32 m0, s45, 150528
    s_add_u32 s31, s43, s51
    buffer_load_dwordx4 v3, s[20:23], s31 offen lds
    s_add_u32 m0, s44, 65536
    s_add_u32 s31, s32, s50
    buffer_load_dwordx4 v3, s[20:23], s31 offen lds
    s_add_u32 m0, s44, 66560
    s_add_u32 s31, s33, s50
    buffer_load_dwordx4 v3, s[20:23], s31 offen lds
    s_add_u32 m0, s44, 67584
    s_add_u32 s31, s34, s50
    buffer_load_dwordx4 v3, s[20:23], s31 offen lds
L_pad6:
    s_cbranch_execz L_pad7
    s_add_u32 m0, s44, 68608
    s_add_u32 s31, s35, s50
    buffer_load_dwordx4 v3, s[20:23], s31 offen lds
    s_add_u32 m0, s44, 69632
    s_add_u32 s31, s36, s50
    buffer_load_dwordx4 v3, s[20:23], s31 offen lds
    s_add_u32 m0, s44, 70656
    s_add_u32 s31, s37, s50
    buffer_load_dwordx4 v3, s[20:23], s31 offen lds
    s_add_u32 m0, s44, 71680
    s_add_u32 s31, s38, s50
    buffer_load_dwordx4 v3, s[20:23], s31 offen lds
    s_add_u32 m0, s44, 72704
    s_add_u32 s31, s39, s50
    buffer_load_dwordx4 v3, s[20:23], s31 offen lds
    s_waitcnt vmcnt(12)
    s_barrier
    s_add_u32 m0, s44, 0
    s_add_u32 s31, s32, s51
    buffer_load_dwordx4 v3, s[20:23], s31 offen lds
    s_add_u32 m0, s44, 1024
    s_add_u32 s31, s33, s51
    buffer_load_dwordx4 v3, s[20:23], s31 offen lds
    s_add_u32 m0, s44, 2048
    s_add_u32 s31, s34, s51
    buffer_load_dwordx4 v3, s[20:23], s31 offen lds
    s_add_u32 m0, s44, 3072
    s_add_u32 s31, s35, s51
    buffer_load_dwordx4 v3, s[20:23], s31 offen lds
    s_add_u32 m0, s44, 4096
    s_add_u32 s31, s36, s51
    buffer_load_dwordx4 v3, s[20:23], s31 offen lds
    s_add_u32 m0, s44, 5120
    s_add_u32 s31, s37, s51
    buffer_load_dwordx4 v3, s[20:23], s31 offen lds
    s_add_u32 m0, s44, 6144
    s_add_u32 s31, s38, s51
    buffer_load_dwordx4 v3, s[20:23], s31 offen lds
    s_add_u32 m0, s44, 7168
L_pad7:
    s_cbranch_execz L_pad8
    s_add_u32 s31, s39, s51
    buffer_load_dwordx4 v3, s[20:23], s31 offen lds
    s_waitcnt vmcnt(8)
    s_barrier
    s_waitcnt vmcnt(0)
    s_barrier
L_end:
    s_endpgm
L_compute:
    s_lshl_b32 s46, s28, 12
    s_lshl_b32 s31, s29, 7
    s_lshl_b32 s52, s28, 5
    s_add_u32 s52, s52, s31
    s_lshl_b32 s52, s52, 9
    s_add_u32 s32, s52, 0
    s_add_u32 s33, s52, 4096
    s_add_u32 s34, s52, 8192
    s_add_u32 s35, s52, 12288
    s_cmp_ge_u32 s28, 3
    s_cselect_b32 s36, -1, 0
    s_cmp_ge_u32 s28, 2
    s_cselect_b32 s37, -1, 0
    s_cmp_ge_u32 s28, 1
    s_cselect_b32 s38, -1, 0
    v_and_b32 v161, 31, v0
    v_lshrrev_b32 v162, 5, v0
    v_bfe_u32 v163, v0, 1, 3
    v_xor_b32 v163, v163, v162
    v_lshlrev_b32 v160, 7, v161
    v_add_u32 v160, s46, v160
    v_xor_b32 v1, 0, v163
    v_lshl_add_u32 v1, v1, 4, v160
    v_xor_b32 v2, 2, v163
    v_lshl_add_u32 v2, v2, 4, v160
    v_xor_b32 v3, 4, v163
    v_lshl_add_u32 v3, v3, 4, v160
    v_xor_b32 v4, 6, v163
    v_lshl_add_u32 v4, v4, 4, v160
    v_bfe_u32 v160, v0, 2, 2
    v_lshl_add_u32 v163, v162, 2, v160
    v_lshlrev_b32 v163, 7, v163
    v_add_u32 v163, s46, v163
    v_lshrrev_b32 v160, 1, v160
    v_lshlrev_b32 v160, 2, v160
    v_and_b32 v161, 1, v0
    v_lshl_add_u32 v160, v161, 1, v160
    v_bfe_u32 v161, v0, 4, 1
    v_add_u32 v160, v160, v161
    v_bfe_u32 v161, v0, 1, 1
    v_lshl_add_u32 v163, v161, 3, v163
    v_lshl_add_u32 v5, v160, 4, v163
    v_xor_b32 v160, 4, v160
    v_lshl_add_u32 v6, v160, 4, v163
    v_and_b32 v161, 15, v0
    v_lshlrev_b32 v161, 9, v161
    v_lshrrev_b32 v163, 4, v0
    v_and_b32 v161, 7, v0
    v_lshlrev_b32 v161, 9, v161
    v_bfe_u32 v164, v0, 3, 1
    v_lshl_add_u32 v161, v164, 6, v161
    v_lshl_add_u32 v14, v163, 4, v161
    v_and_b32 v161, 31, v0
    v_lshlrev_b32 v163, 2, v162
    v_sub_u32 v161, v161, v163
    v_mov_b32 v164, 0xff800000
    s_lshl_b32 s31, s29, 2
    s_add_u32 s31, s31, s28
    s_cmp_ge_u32 s31, 8
    s_cselect_b32 s52, 0, 0xff800000
    v_mov_b32 v163, s52
    s_cmp_ge_u32 s31, 7
    s_cselect_b32 s52, 0, 0xff800000
    v_mov_b32 v32, s52
    v_mov_b32 v33, s52
    v_mov_b32 v34, s52
    v_mov_b32 v35, s52
    v_mov_b32 v36, s52
    v_mov_b32 v37, s52
    v_mov_b32 v38, s52
    v_mov_b32 v39, s52
    v_mov_b32 v40, s52
    v_mov_b32 v41, s52
    v_mov_b32 v42, s52
    v_mov_b32 v43, s52
    v_mov_b32 v44, s52
    v_mov_b32 v45, s52
    v_mov_b32 v46, s52
    v_mov_b32 v47, s52
    s_cmp_ge_u32 s31, 6
    s_cselect_b32 s52, 0, 0xff800000
    v_mov_b32 v48, s52
    v_mov_b32 v49, s52
    v_mov_b32 v50, s52
    v_mov_b32 v51, s52
    v_mov_b32 v52, s52
    v_mov_b32 v53, s52
    v_mov_b32 v54, s52
    v_mov_b32 v55, s52
    v_mov_b32 v56, s52
    v_mov_b32 v57, s52
    v_mov_b32 v58, s52
    v_mov_b32 v59, s52
    v_mov_b32 v60, s52
    v_mov_b32 v61, s52
    v_mov_b32 v62, s52
    v_mov_b32 v63, s52
    s_cmp_ge_u32 s31, 5
    s_cselect_b32 s52, 0, 0xff800000
    v_mov_b32 v64, s52
    v_mov_b32 v65, s52
    v_mov_b32 v66, s52
    v_mov_b32 v67, s52
    v_mov_b32 v68, s52
    v_mov_b32 v69, s52
    v_mov_b32 v70, s52
    v_mov_b32 v71, s52
    v_mov_b32 v72, s52
    v_mov_b32 v73, s52
    v_mov_b32 v74, s52
    v_mov_b32 v75, s52
    v_mov_b32 v76, s52
    v_mov_b32 v77, s52
    v_mov_b32 v78, s52
    v_mov_b32 v79, s52
    s_cmp_ge_u32 s31, 4
    s_cselect_b32 s52, 0, 0xff800000
    v_mov_b32 v80, s52
    v_mov_b32 v81, s52
    v_mov_b32 v82, s52
    v_mov_b32 v83, s52
    v_mov_b32 v84, s52
    v_mov_b32 v85, s52
    v_mov_b32 v86, s52
    v_mov_b32 v87, s52
    v_mov_b32 v88, s52
    v_mov_b32 v89, s52
    v_mov_b32 v90, s52
    v_mov_b32 v91, s52
    v_mov_b32 v92, s52
    v_mov_b32 v93, s52
    v_mov_b32 v94, s52
    v_mov_b32 v95, s52
    s_cmp_ge_u32 s31, 3
    s_cselect_b32 s52, 0, 0xff800000
    v_mov_b32 v96, s52
    v_mov_b32 v97, s52
    v_mov_b32 v98, s52
    v_mov_b32 v99, s52
    v_mov_b32 v100, s52
    v_mov_b32 v101, s52
    v_mov_b32 v102, s52
    v_mov_b32 v103, s52
    v_mov_b32 v104, s52
    v_mov_b32 v105, s52
    v_mov_b32 v106, s52
    v_mov_b32 v107, s52
    v_mov_b32 v108, s52
    v_mov_b32 v109, s52
    v_mov_b32 v110, s52
    v_mov_b32 v111, s52
    s_cmp_ge_u32 s31, 2
    s_cselect_b32 s52, 0, 0xff800000
    v_mov_b32 v112, s52
    v_mov_b32 v113, s52
    v_mov_b32 v114, s52
    v_mov_b32 v115, s52
    v_mov_b32 v116, s52
    v_mov_b32 v117, s52
    v_mov_b32 v118, s52
    v_mov_b32 v119, s52
    v_mov_b32 v120, s52
    v_mov_b32 v121, s52
    v_mov_b32 v122, s52
    v_mov_b32 v123, s52
    v_mov_b32 v124, s52
    v_mov_b32 v125, s52
    v_mov_b32 v126, s52
    v_mov_b32 v127, s52
    s_cmp_ge_u32 s31, 1
    s_cselect_b32 s52, 0, 0xff800000
    v_mov_b32 v128, s52
    v_mov_b32 v129, s52
    v_mov_b32 v130, s52
    v_mov_b32 v131, s52
    v_mov_b32 v132, s52
    v_mov_b32 v133, s52
    v_mov_b32 v134, s52
    v_mov_b32 v135, s52
    v_mov_b32 v136, s52
    v_mov_b32 v137, s52
    v_mov_b32 v138, s52
    v_mov_b32 v139, s52
    v_mov_b32 v140, s52
    v_mov_b32 v141, s52
    v_mov_b32 v142, s52
    v_mov_b32 v143, s52
    v_mov_b32 v162, 0
    v_cmp_gt_i32 vcc, 0, v161
    v_cmp_gt_i32 s[60:61], 1, v161
    s_nop 0
    v_cndmask_b32 v16, v164, v163, vcc
    v_cndmask_b32 v144, v162, v164, vcc
    v_cndmask_b32 v17, v164, v163, s[60:61]
    v_cndmask_b32 v145, v162, v164, s[60:61]
    v_cmp_gt_i32 vcc, 2, v161
    v_cmp_gt_i32 s[60:61], 3, v161
    s_nop 0
    v_cndmask_b32 v18, v164, v163, vcc
    v_cndmask_b32 v146, v162, v164, vcc
    v_cndmask_b32 v19, v164, v163, s[60:61]
    v_cndmask_b32 v147, v162, v164, s[60:61]
    v_cmp_gt_i32 vcc, 8, v161
    v_cmp_gt_i32 s[60:61], 9, v161
    s_nop 0
    v_cndmask_b32 v20, v164, v163, vcc
    v_cndmask_b32 v148, v162, v164, vcc
    v_cndmask_b32 v21, v164, v163, s[60:61]
    v_cndmask_b32 v149, v162, v164, s[60:61]
    v_cmp_gt_i32 vcc, 10, v161
    v_cmp_gt_i32 s[60:61], 11, v161
    s_nop 0
    v_cndmask_b32 v22, v164, v163, vcc
    v_cndmask_b32 v150, v162, v164, vcc
    v_cndmask_b32 v23, v164, v163, s[60:61]
    v_cndmask_b32 v151, v162, v164, s[60:61]
    v_cmp_gt_i32 vcc, 16, v161
    v_cmp_gt_i32 s[60:61], 17, v161
    s_nop 0
    v_cndmask_b32 v24, v164, v163, vcc
    v_cndmask_b32 v152, v162, v164, vcc
    v_cndmask_b32 v25, v164, v163, s[60:61]
    v_cndmask_b32 v153, v162, v164, s[60:61]
    v_cmp_gt_i32 vcc, 18, v161
    v_cmp_gt_i32 s[60:61], 19, v161
    s_nop 0
    v_cndmask_b32 v26, v164, v163, vcc
    v_cndmask_b32 v154, v162, v164, vcc
    v_cndmask_b32 v27, v164, v163, s[60:61]
    v_cndmask_b32 v155, v162, v164, s[60:61]
    v_cmp_gt_i32 vcc, 24, v161
    v_cmp_gt_i32 s[60:61], 25, v161
    s_nop 0
    v_cndmask_b32 v28, v164, v163, vcc
    v_cndmask_b32 v156, v162, v164, vcc
    v_cndmask_b32 v29, v164, v163, s[60:61]
    v_cndmask_b32 v157, v162, v164, s[60:61]
    v_cmp_gt_i32 vcc, 26, v161
    v_cmp_gt_i32 s[60:61], 27, v161
    s_nop 0
    v_cndmask_b32 v30, v164, v163, vcc
    v_cndmask_b32 v158, v162, v164, vcc
    v_cndmask_b32 v31, v164, v163, s[60:61]
    v_cndmask_b32 v159, v162, v164, s[60:61]
    v_mov_b32 v160, 0x3f803f80
    v_accvgpr_write_b32 a48, v160
    v_accvgpr_write_b32 a49, v160
    v_accvgpr_write_b32 a50, v160
    v_accvgpr_write_b32 a51, v160
    s_mov_b32 s54, 0x3db8aa3b
    s_waitcnt lgkmcnt(0)
    s_lshl_b32 s31, s30, 20
    s_add_u32 s24, s10, s31
    s_addc_u32 s25, s11, 0
    s_mov_b32 s26, 1048576
    s_mov_b32 s27, 131072
    s_mov_b32 s40, s24
    s_mov_b32 s41, s25
    s_mov_b64 exec, 0
    s_cmp_eq_u32 s28, 0
    s_cbranch_scc1 L_pad0
    s_cmp_eq_u32 s28, 1
    s_cbranch_scc1 L_pad15
    s_cmp_eq_u32 s28, 2
    s_cbranch_scc1 L_pad30
    s_cmp_eq_u32 s28, 3
    s_cbranch_scc1 L_pad45
L_hopdone:
    s_mov_b64 exec, -1
    s_nop 3
L_pad8:
    s_cbranch_execz L_pad9
    s_barrier
    v_add_u32 v7, 81920, v1
    v_add_u32 v8, 81920, v2
    v_add_u32 v9, 81920, v3
    v_add_u32 v10, 81920, v4
    ds_read_b128 v[160:163], v7
    ds_read_b128 v[164:167], v8
    ds_read_b128 v[168:171], v9
    ds_read_b128 v[172:175], v10
    ds_read_b128 a[0:3], v1
    ds_read_b128 a[4:7], v2
    ds_read_b128 a[8:11], v3
    ds_read_b128 a[12:15], v4
    ds_read_b128 a[16:19], v1 offset:4096
    ds_read_b128 a[20:23], v2 offset:4096
    s_waitcnt lgkmcnt(4)
    v_mfma_f32_32x32x16_bf16 v[16:31], a[0:3], v[160:163], v[16:31]
    ds_read_b128 a[24:27], v3 offset:4096
    v_mfma_f32_32x32x16_bf16 v[16:31], a[4:7], v[164:167], v[16:31]
    ds_read_b128 a[28:31], v4 offset:4096
    s_waitcnt lgkmcnt(4)
    v_mfma_f32_32x32x16_bf16 v[16:31], a[8:11], v[168:171], v[16:31]
    ds_read_b128 a[0:3], v1 offset:8192
    v_mfma_f32_32x32x16_bf16 v[16:31], a[12:15], v[172:175], v[16:31]
    ds_read_b128 a[4:7], v2 offset:8192
    s_waitcnt lgkmcnt(4)
    v_mfma_f32_32x32x16_bf16 v[32:47], a[16:19], v[160:163], v[32:47]
    ds_read_b128 a[8:11], v3 offset:8192
    v_mfma_f32_32x32x16_bf16 v[32:47], a[20:23], v[164:167], v[32:47]
    ds_read_b128 a[12:15], v4 offset:8192
    s_waitcnt lgkmcnt(4)
    v_mfma_f32_32x32x16_bf16 v[32:47], a[24:27], v[168:171], v[32:47]
    ds_read_b128 a[16:19], v1 offset:12288
    v_mfma_f32_32x32x16_bf16 v[32:47], a[28:31], v[172:175], v[32:47]
L_pad9:
    s_cbranch_execz L_pad10
    ds_read_b128 a[20:23], v2 offset:12288
    s_waitcnt lgkmcnt(4)
    v_mfma_f32_32x32x16_bf16 v[48:63], a[0:3], v[160:163], v[48:63]
    ds_read_b128 a[24:27], v3 offset:12288
    v_mfma_f32_32x32x16_bf16 v[48:63], a[4:7], v[164:167], v[48:63]
    ds_read_b128 a[28:31], v4 offset:12288
    s_waitcnt lgkmcnt(4)
    v_mfma_f32_32x32x16_bf16 v[48:63], a[8:11], v[168:171], v[48:63]
    ds_read_b128 a[0:3], v1 offset:16384
    v_mfma_f32_32x32x16_bf16 v[48:63], a[12:15], v[172:175], v[48:63]
    ds_read_b128 a[4:7], v2 offset:16384
    s_waitcnt lgkmcnt(4)
    v_mfma_f32_32x32x16_bf16 v[64:79], a[16:19], v[160:163], v[64:79]
    ds_read_b128 a[8:11], v3 offset:16384
    v_mfma_f32_32x32x16_bf16 v[64:79], a[20:23], v[164:167], v[64:79]
    ds_read_b128 a[12:15], v4 offset:16384
    s_waitcnt lgkmcnt(4)
    v_mfma_f32_32x32x16_bf16 v[64:79], a[24:27], v[168:171], v[64:79]
    s_and_b32 s31, s36, 0x8000
    v_add_u32 v7, s31, v1
    v_add_u32 v8, s31, v2
    v_add_u32 v9, s31, v3
    v_add_u32 v10, s31, v4
    ds_read_b128 a[16:19], v7 offset:20480
    v_mfma_f32_32x32x16_bf16 v[64:79], a[28:31], v[172:175], v[64:79]
    ds_read_b128 a[20:23], v8 offset:20480
    s_waitcnt lgkmcnt(4)
    v_mfma_f32_32x32x16_bf16 v[80:95], a[0:3], v[160:163], v[80:95]
    ds_read_b128 a[24:27], v9 offset:20480
    v_mfma_f32_32x32x16_bf16 v[80:95], a[4:7], v[164:167], v[80:95]
    ds_read_b128 a[28:31], v10 offset:20480
    s_waitcnt lgkmcnt(4)
    v_mfma_f32_32x32x16_bf16 v[80:95], a[8:11], v[168:171], v[80:95]
    s_and_b32 s31, s37, 0x8000
    v_add_u32 v7, s31, v1
    v_add_u32 v8, s31, v2
    v_add_u32 v9, s31, v3
    v_add_u32 v10, s31, v4
    ds_read_b128 a[0:3], v7 offset:24576
L_pad10:
    s_cbranch_execz L_pad11
    v_mfma_f32_32x32x16_bf16 v[80:95], a[12:15], v[172:175], v[80:95]
    ds_read_b128 a[4:7], v8 offset:24576
    s_waitcnt lgkmcnt(4)
    v_mfma_f32_32x32x16_bf16 v[96:111], a[16:19], v[160:163], v[96:111]
    ds_read_b128 a[8:11], v9 offset:24576
    v_mfma_f32_32x32x16_bf16 v[96:111], a[20:23], v[164:167], v[96:111]
    ds_read_b128 a[12:15], v10 offset:24576
    s_waitcnt lgkmcnt(4)
    v_mfma_f32_32x32x16_bf16 v[96:111], a[24:27], v[168:171], v[96:111]
    s_and_b32 s31, s38, 0x8000
    v_add_u32 v7, s31, v1
    v_add_u32 v8, s31, v2
    v_add_u32 v9, s31, v3
    v_add_u32 v10, s31, v4
    ds_read_b128 a[16:19], v7 offset:28672
    v_mfma_f32_32x32x16_bf16 v[96:111], a[28:31], v[172:175], v[96:111]
    ds_read_b128 a[20:23], v8 offset:28672
    s_waitcnt lgkmcnt(4)
    v_mfma_f32_32x32x16_bf16 v[112:127], a[0:3], v[160:163], v[112:127]
    ds_read_b128 a[24:27], v9 offset:28672
    v_mfma_f32_32x32x16_bf16 v[112:127], a[4:7], v[164:167], v[112:127]
    ds_read_b128 a[28:31], v10 offset:28672
    s_waitcnt lgkmcnt(4)
    v_mfma_f32_32x32x16_bf16 v[112:127], a[8:11], v[168:171], v[112:127]
    v_add_u32 v7, 65536, v1
    v_add_u32 v8, 65536, v2
    v_add_u32 v9, 65536, v3
    v_add_u32 v10, 65536, v4
    ds_read_b128 a[0:3], v7
    v_mfma_f32_32x32x16_bf16 v[112:127], a[12:15], v[172:175], v[112:127]
    ds_read_b128 a[4:7], v8
    s_waitcnt lgkmcnt(4)
    v_mfma_f32_32x32x16_bf16 v[128:143], a[16:19], v[160:163], v[128:143]
    ds_read_b128 a[8:11], v9
    v_mfma_f32_32x32x16_bf16 v[128:143], a[20:23], v[164:167], v[128:143]
    ds_read_b128 a[12:15], v10
L_pad11:
    s_cbranch_execz L_pad12
    s_waitcnt lgkmcnt(4)
    v_mfma_f32_32x32x16_bf16 v[128:143], a[24:27], v[168:171], v[128:143]
    v_mfma_f32_32x32x16_bf16 v[128:143], a[28:31], v[172:175], v[128:143]
    s_waitcnt lgkmcnt(2)
    v_mfma_f32_32x32x16_bf16 v[144:159], a[0:3], v[160:163], v[144:159]
    v_mfma_f32_32x32x16_bf16 v[144:159], a[4:7], v[164:167], v[144:159]
    s_waitcnt lgkmcnt(0)
    s_barrier
    v_add_u32 v7, 114688, v1
    v_add_u32 v8, 114688, v2
    v_add_u32 v9, 114688, v3
    v_add_u32 v10, 114688, v4
    ds_read_b128 v[176:179], v7
    ds_read_b128 v[180:183], v8
    ds_read_b128 v[184:187], v9
    ds_read_b128 v[188:191], v10
    ds_read_b128 a[16:19], v1 offset:32768
    ds_read_b128 a[20:23], v2 offset:32768
    ds_read_b128 a[24:27], v3 offset:32768
    v_mfma_f32_32x32x16_bf16 v[144:159], a[8:11], v[168:171], v[144:159]
    ds_read_b128 a[28:31], v4 offset:32768
    ds_read_b128 a[0:3], v1 offset:36864
    v_mfma_f32_32x32x16_bf16 v[144:159], a[12:15], v[172:175], v[144:159]
    ds_read_b128 a[4:7], v2 offset:36864
    s_waitcnt lgkmcnt(4)
    v_mfma_f32_32x32x16_bf16 v[16:31], a[16:19], v[176:179], v[16:31]
    ds_read_b128 a[8:11], v3 offset:36864
    v_mfma_f32_32x32x16_bf16 v[16:31], a[20:23], v[180:183], v[16:31]
    ds_read_b128 a[12:15], v4 offset:36864
    s_waitcnt lgkmcnt(4)
    v_mfma_f32_32x32x16_bf16 v[16:31], a[24:27], v[184:187], v[16:31]
    ds_read_b128 a[16:19], v1 offset:40960
    v_mfma_f32_32x32x16_bf16 v[16:31], a[28:31], v[188:191], v[16:31]
    ds_read_b128 a[20:23], v2 offset:40960
    s_waitcnt lgkmcnt(4)
L_pad12:
    s_cbranch_execz L_pad13
    v_mfma_f32_32x32x16_bf16 v[32:47], a[0:3], v[176:179], v[32:47]
    ds_read_b128 a[24:27], v3 offset:40960
    v_mfma_f32_32x32x16_bf16 v[32:47], a[4:7], v[180:183], v[32:47]
    ds_read_b128 a[28:31], v4 offset:40960
    s_waitcnt lgkmcnt(4)
    v_mfma_f32_32x32x16_bf16 v[32:47], a[8:11], v[184:187], v[32:47]
    ds_read_b128 a[0:3], v1 offset:45056
    v_mfma_f32_32x32x16_bf16 v[32:47], a[12:15], v[188:191], v[32:47]
    ds_read_b128 a[4:7], v2 offset:45056
    s_waitcnt lgkmcnt(4)
    v_mfma_f32_32x32x16_bf16 v[48:63], a[16:19], v[176:179], v[48:63]
    ds_read_b128 a[8:11], v3 offset:45056
    v_mfma_f32_32x32x16_bf16 v[48:63], a[20:23], v[180:183], v[48:63]
    ds_read_b128 a[12:15], v4 offset:45056
    s_waitcnt lgkmcnt(4)
    v_mfma_f32_32x32x16_bf16 v[48:63], a[24:27], v[184:187], v[48:63]
    ds_read_b128 a[16:19], v1 offset:49152
    v_mfma_f32_32x32x16_bf16 v[48:63], a[28:31], v[188:191], v[48:63]
    ds_read_b128 a[20:23], v2 offset:49152
    s_waitcnt lgkmcnt(4)
    v_mfma_f32_32x32x16_bf16 v[64:79], a[0:3], v[176:179], v[64:79]
    ds_read_b128 a[24:27], v3 offset:49152
    v_mfma_f32_32x32x16_bf16 v[64:79], a[4:7], v[180:183], v[64:79]
    ds_read_b128 a[28:31], v4 offset:49152
    s_waitcnt lgkmcnt(4)
    v_mfma_f32_32x32x16_bf16 v[64:79], a[8:11], v[184:187], v[64:79]
    s_and_b32 s31, s36, 0x8000
    v_add_u32 v7, s31, v1
    v_add_u32 v8, s31, v2
    v_add_u32 v9, s31, v3
    v_add_u32 v10, s31, v4
    ds_read_b128 a[0:3], v7 offset:53248
    v_mfma_f32_32x32x16_bf16 v[64:79], a[12:15], v[188:191], v[64:79]
    ds_read_b128 a[4:7], v8 offset:53248
    s_waitcnt lgkmcnt(4)
    v_mfma_f32_32x32x16_bf16 v[80:95], a[16:19], v[176:179], v[80:95]
    ds_read_b128 a[8:11], v9 offset:53248
L_pad13:
    s_cbranch_execz L_pad14
    v_mfma_f32_32x32x16_bf16 v[80:95], a[20:23], v[180:183], v[80:95]
    ds_read_b128 a[12:15], v10 offset:53248
    s_waitcnt lgkmcnt(4)
    v_mfma_f32_32x32x16_bf16 v[80:95], a[24:27], v[184:187], v[80:95]
    s_and_b32 s31, s37, 0x8000
    v_add_u32 v7, s31, v1
    v_add_u32 v8, s31, v2
    v_add_u32 v9, s31, v3
    v_add_u32 v10, s31, v4
    ds_read_b128 a[16:19], v7 offset:57344
    v_mfma_f32_32x32x16_bf16 v[80:95], a[28:31], v[188:191], v[80:95]
    ds_read_b128 a[20:23], v8 offset:57344
    s_waitcnt lgkmcnt(4)
    v_mfma_f32_32x32x16_bf16 v[96:111], a[0:3], v[176:179], v[96:111]
    ds_read_b128 a[24:27], v9 offset:57344
    v_mfma_f32_32x32x16_bf16 v[96:111], a[4:7], v[180:183], v[96:111]
    ds_read_b128 a[28:31], v10 offset:57344
    s_waitcnt lgkmcnt(4)
    v_mfma_f32_32x32x16_bf16 v[96:111], a[8:11], v[184:187], v[96:111]
    s_and_b32 s31, s38, 0x8000
    v_add_u32 v7, s31, v1
    v_add_u32 v8, s31, v2
    v_add_u32 v9, s31, v3
    v_add_u32 v10, s31, v4
    ds_read_b128 a[0:3], v7 offset:61440
    v_mfma_f32_32x32x16_bf16 v[96:111], a[12:15], v[188:191], v[96:111]
    ds_read_b128 a[4:7], v8 offset:61440
    s_waitcnt lgkmcnt(4)
    v_mfma_f32_32x32x16_bf16 v[112:127], a[16:19], v[176:179], v[112:127]
    ds_read_b128 a[8:11], v9 offset:61440
    v_mfma_f32_32x32x16_bf16 v[112:127], a[20:23], v[180:183], v[112:127]
    ds_read_b128 a[12:15], v10 offset:61440
    s_waitcnt lgkmcnt(4)
    v_mfma_f32_32x32x16_bf16 v[112:127], a[24:27], v[184:187], v[112:127]
    v_add_u32 v7, 98304, v1
    v_add_u32 v8, 98304, v2
    v_add_u32 v9, 98304, v3
    v_add_u32 v10, 98304, v4
L_pad14:
    s_cbranch_execz L_hopdone
    ds_read_b128 a[16:19], v7
    v_mfma_f32_32x32x16_bf16 v[112:127], a[28:31], v[188:191], v[112:127]
    ds_read_b128 a[20:23], v8
    s_waitcnt lgkmcnt(4)
    v_mfma_f32_32x32x16_bf16 v[128:143], a[0:3], v[176:179], v[128:143]
    ds_read_b128 a[24:27], v9
    v_mfma_f32_32x32x16_bf16 v[128:143], a[4:7], v[180:183], v[128:143]
    ds_read_b128 a[28:31], v10
    s_waitcnt lgkmcnt(4)
    v_mfma_f32_32x32x16_bf16 v[128:143], a[8:11], v[184:187], v[128:143]
    v_mfma_f32_32x32x16_bf16 v[128:143], a[12:15], v[188:191], v[128:143]
    s_waitcnt lgkmcnt(2)
    v_mfma_f32_32x32x16_bf16 v[144:159], a[16:19], v[176:179], v[144:159]
    v_mfma_f32_32x32x16_bf16 v[144:159], a[20:23], v[180:183], v[144:159]
    s_waitcnt lgkmcnt(0)
    s_barrier
    v_add_u32 v7, 147456, v1
    v_add_u32 v8, 147456, v2
    v_add_u32 v9, 147456, v3
    v_add_u32 v10, 147456, v4
    ds_read_b128 v[160:163], v7
    ds_read_b128 v[164:167], v8
    ds_read_b128 v[168:171], v9
    ds_read_b128 v[172:175], v10
    ds_read_b128 a[0:3], v1
    ds_read_b128 a[4:7], v2
    ds_read_b128 a[8:11], v3
    v_mfma_f32_32x32x16_bf16 v[144:159], a[24:27], v[184:187], v[144:159]
    ds_read_b128 a[12:15], v4
    ds_read_b128 a[16:19], v1 offset:4096
    v_mfma_f32_32x32x16_bf16 v[144:159], a[28:31], v[188:191], v[144:159]
    ds_read_b128 a[20:23], v2 offset:4096
    s_waitcnt lgkmcnt(4)
    v_mfma_f32_32x32x16_bf16 v[16:31], a[0:3], v[160:163], v[16:31]
    ds_read_b128 a[24:27], v3 offset:4096
L_pad15:
    s_cbranch_execz L_pad16
    v_mfma_f32_32x32x16_bf16 v[16:31], a[4:7], v[164:167], v[16:31]
    ds_read_b128 a[28:31], v4 offset:4096
    s_waitcnt lgkmcnt(4)
    v_mfma_f32_32x32x16_bf16 v[16:31], a[8:11], v[168:171], v[16:31]
    ds_read_b128 a[0:3], v1 offset:8192
    v_mfma_f32_32x32x16_bf16 v[16:31], a[12:15], v[172:175], v[16:31]
    ds_read_b128 a[4:7], v2 offset:8192
    s_waitcnt lgkmcnt(4)
    v_mfma_f32_32x32x16_bf16 v[32:47], a[16:19], v[160:163], v[32:47]
    ds_read_b128 a[8:11], v3 offset:8192
    v_mfma_f32_32x32x16_bf16 v[32:47], a[20:23], v[164:167], v[32:47]
    ds_read_b128 a[12:15], v4 offset:8192
    s_waitcnt lgkmcnt(4)
    v_mfma_f32_32x32x16_bf16 v[32:47], a[24:27], v[168:171], v[32:47]
    ds_read_b128 a[16:19], v1 offset:12288
    v_mfma_f32_32x32x16_bf16 v[32:47], a[28:31], v[172:175], v[32:47]
    ds_read_b128 a[20:23], v2 offset:12288
    s_waitcnt lgkmcnt(4)
    v_mfma_f32_32x32x16_bf16 v[48:63], a[0:3], v[160:163], v[48:63]
    ds_read_b128 a[24:27], v3 offset:12288
    v_mfma_f32_32x32x16_bf16 v[48:63], a[4:7], v[164:167], v[48:63]
    ds_read_b128 a[28:31], v4 offset:12288
    s_waitcnt lgkmcnt(4)
    v_mfma_f32_32x32x16_bf16 v[48:63], a[8:11], v[168:171], v[48:63]
    ds_read_b128 a[0:3], v1 offset:16384
    v_mfma_f32_32x32x16_bf16 v[48:63], a[12:15], v[172:175], v[48:63]
    ds_read_b128 a[4:7], v2 offset:16384
    s_waitcnt lgkmcnt(4)
    v_mfma_f32_32x32x16_bf16 v[64:79], a[16:19], v[160:163], v[64:79]
    ds_read_b128 a[8:11], v3 offset:16384
    v_mfma_f32_32x32x16_bf16 v[64:79], a[20:23], v[164:167], v[64:79]
    ds_read_b128 a[12:15], v4 offset:16384
    s_waitcnt lgkmcnt(4)
    v_mfma_f32_32x32x16_bf16 v[64:79], a[24:27], v[168:171], v[64:79]
    s_and_b32 s31, s36, 0x18000
L_pad16:
    s_cbranch_execz L_pad17
    v_add_u32 v7, s31, v1
    v_add_u32 v8, s31, v2
    v_add_u32 v9, s31, v3
    v_add_u32 v10, s31, v4
    ds_read_b128 a[16:19], v7 offset:20480
    v_mfma_f32_32x32x16_bf16 v[64:79], a[28:31], v[172:175], v[64:79]
    ds_read_b128 a[20:23], v8 offset:20480
    s_waitcnt lgkmcnt(4)
    v_mfma_f32_32x32x16_bf16 v[80:95], a[0:3], v[160:163], v[80:95]
    ds_read_b128 a[24:27], v9 offset:20480
    v_mfma_f32_32x32x16_bf16 v[80:95], a[4:7], v[164:167], v[80:95]
    ds_read_b128 a[28:31], v10 offset:20480
    s_waitcnt lgkmcnt(4)
    v_mfma_f32_32x32x16_bf16 v[80:95], a[8:11], v[168:171], v[80:95]
    s_and_b32 s31, s37, 0x18000
    v_add_u32 v7, s31, v1
    v_add_u32 v8, s31, v2
    v_add_u32 v9, s31, v3
    v_add_u32 v10, s31, v4
    ds_read_b128 a[0:3], v7 offset:24576
    v_mfma_f32_32x32x16_bf16 v[80:95], a[12:15], v[172:175], v[80:95]
    ds_read_b128 a[4:7], v8 offset:24576
    s_waitcnt lgkmcnt(4)
    v_mfma_f32_32x32x16_bf16 v[96:111], a[16:19], v[160:163], v[96:111]
    ds_read_b128 a[8:11], v9 offset:24576
    v_mfma_f32_32x32x16_bf16 v[96:111], a[20:23], v[164:167], v[96:111]
    ds_read_b128 a[12:15], v10 offset:24576
    s_waitcnt lgkmcnt(4)
    v_mfma_f32_32x32x16_bf16 v[96:111], a[24:27], v[168:171], v[96:111]
    s_and_b32 s31, s38, 0x18000
    v_add_u32 v7, s31, v1
    v_add_u32 v8, s31, v2
    v_add_u32 v9, s31, v3
    v_add_u32 v10, s31, v4
    ds_read_b128 a[16:19], v7 offset:28672
    v_mfma_f32_32x32x16_bf16 v[96:111], a[28:31], v[172:175], v[96:111]
    ds_read_b128 a[20:23], v8 offset:28672
    s_waitcnt lgkmcnt(4)
    v_mfma_f32_32x32x16_bf16 v[112:127], a[0:3], v[160:163], v[112:127]
    ds_read_b128 a[24:27], v9 offset:28672
L_pad17:
    s_cbranch_execz L_pad18
    v_mfma_f32_32x32x16_bf16 v[112:127], a[4:7], v[164:167], v[112:127]
    ds_read_b128 a[28:31], v10 offset:28672
    s_waitcnt lgkmcnt(4)
    v_mfma_f32_32x32x16_bf16 v[112:127], a[8:11], v[168:171], v[112:127]
    v_add_u32 v7, 131072, v1
    v_add_u32 v8, 131072, v2
    v_add_u32 v9, 131072, v3
    v_add_u32 v10, 131072, v4
    ds_read_b128 a[0:3], v7
    v_mfma_f32_32x32x16_bf16 v[112:127], a[12:15], v[172:175], v[112:127]
    ds_read_b128 a[4:7], v8
    s_waitcnt lgkmcnt(4)
    v_mfma_f32_32x32x16_bf16 v[128:143], a[16:19], v[160:163], v[128:143]
    ds_read_b128 a[8:11], v9
    v_mfma_f32_32x32x16_bf16 v[128:143], a[20:23], v[164:167], v[128:143]
    ds_read_b128 a[12:15], v10
    s_waitcnt lgkmcnt(4)
    v_mfma_f32_32x32x16_bf16 v[128:143], a[24:27], v[168:171], v[128:143]
    v_mfma_f32_32x32x16_bf16 v[128:143], a[28:31], v[172:175], v[128:143]
    s_waitcnt lgkmcnt(2)
    v_mfma_f32_32x32x16_bf16 v[144:159], a[0:3], v[160:163], v[144:159]
    v_mfma_f32_32x32x16_bf16 v[144:159], a[4:7], v[164:167], v[144:159]
    s_waitcnt lgkmcnt(0)
    s_barrier
    v_add_u32 v7, 81920, v1
    v_add_u32 v8, 81920, v2
    v_add_u32 v9, 81920, v3
    v_add_u32 v10, 81920, v4
    ds_read_b128 v[176:179], v7
    ds_read_b128 v[180:183], v8
    ds_read_b128 v[184:187], v9
    ds_read_b128 v[188:191], v10
    ds_read_b128 a[16:19], v1 offset:32768
    ds_read_b128 a[20:23], v2 offset:32768
    ds_read_b128 a[24:27], v3 offset:32768
L_pad18:
    s_cbranch_execz L_pad19
    v_mfma_f32_32x32x16_bf16 v[144:159], a[8:11], v[168:171], v[144:159]
    ds_read_b128 a[28:31], v4 offset:32768
    ds_read_b128 a[0:3], v1 offset:36864
    v_mfma_f32_32x32x16_bf16 v[144:159], a[12:15], v[172:175], v[144:159]
    ds_read_b128 a[4:7], v2 offset:36864
    s_waitcnt lgkmcnt(4)
    v_mfma_f32_32x32x16_bf16 v[16:31], a[16:19], v[176:179], v[16:31]
    ds_read_b128 a[8:11], v3 offset:36864
    v_mfma_f32_32x32x16_bf16 v[16:31], a[20:23], v[180:183], v[16:31]
    ds_read_b128 a[12:15], v4 offset:36864
    s_waitcnt lgkmcnt(4)
    v_mfma_f32_32x32x16_bf16 v[16:31], a[24:27], v[184:187], v[16:31]
    ds_read_b128 a[16:19], v1 offset:40960
    v_mfma_f32_32x32x16_bf16 v[16:31], a[28:31], v[188:191], v[16:31]
    ds_read_b128 a[20:23], v2 offset:40960
    s_waitcnt lgkmcnt(4)
    v_mfma_f32_32x32x16_bf16 v[32:47], a[0:3], v[176:179], v[32:47]
    ds_read_b128 a[24:27], v3 offset:40960
    v_mfma_f32_32x32x16_bf16 v[32:47], a[4:7], v[180:183], v[32:47]
    ds_read_b128 a[28:31], v4 offset:40960
    s_waitcnt lgkmcnt(4)
    v_mfma_f32_32x32x16_bf16 v[32:47], a[8:11], v[184:187], v[32:47]
    ds_read_b128 a[0:3], v1 offset:45056
    v_mfma_f32_32x32x16_bf16 v[32:47], a[12:15], v[188:191], v[32:47]
    ds_read_b128 a[4:7], v2 offset:45056
    s_waitcnt lgkmcnt(4)
    v_mfma_f32_32x32x16_bf16 v[48:63], a[16:19], v[176:179], v[48:63]
    ds_read_b128 a[8:11], v3 offset:45056
    v_max_f32 v15, v16, v17
    v_max_f32 v192, v18, v19
    v_mfma_f32_32x32x16_bf16 v[48:63], a[20:23], v[180:183], v[48:63]
    ds_read_b128 a[12:15], v4 offset:45056
    v_max3_f32 v15, v15, v20, v21
    v_max3_f32 v192, v192, v22, v23
    s_waitcnt lgkmcnt(4)
    v_mfma_f32_32x32x16_bf16 v[48:63], a[24:27], v[184:187], v[48:63]
L_pad19:
    s_cbranch_execz L_pad20
    ds_read_b128 a[16:19], v1 offset:49152
    v_max3_f32 v15, v15, v24, v25
    v_max3_f32 v192, v192, v26, v27
    v_mfma_f32_32x32x16_bf16 v[48:63], a[28:31], v[188:191], v[48:63]
    ds_read_b128 a[20:23], v2 offset:49152
    v_max3_f32 v15, v15, v28, v29
    v_max3_f32 v192, v192, v30, v31
    s_waitcnt lgkmcnt(4)
    v_mfma_f32_32x32x16_bf16 v[64:79], a[0:3], v[176:179], v[64:79]
    ds_read_b128 a[24:27], v3 offset:49152
    v_max3_f32 v15, v15, v32, v33
    v_max3_f32 v192, v192, v34, v35
    v_mfma_f32_32x32x16_bf16 v[64:79], a[4:7], v[180:183], v[64:79]
    ds_read_b128 a[28:31], v4 offset:49152
    v_max3_f32 v15, v15, v36, v37
    v_max3_f32 v192, v192, v38, v39
    s_waitcnt lgkmcnt(4)
    v_mfma_f32_32x32x16_bf16 v[64:79], a[8:11], v[184:187], v[64:79]
    s_and_b32 s31, s36, 0x0
    v_add_u32 v7, s31, v1
    v_add_u32 v8, s31, v2
    v_add_u32 v9, s31, v3
    v_add_u32 v10, s31, v4
    ds_read_b128 a[0:3], v7 offset:53248
    v_max3_f32 v15, v15, v40, v41
    v_max3_f32 v192, v192, v42, v43
    v_mfma_f32_32x32x16_bf16 v[64:79], a[12:15], v[188:191], v[64:79]
    ds_read_b128 a[4:7], v8 offset:53248
    v_max3_f32 v15, v15, v44, v45
    v_max3_f32 v192, v192, v46, v47
    s_waitcnt lgkmcnt(4)
    v_mfma_f32_32x32x16_bf16 v[80:95], a[16:19], v[176:179], v[80:95]
    ds_read_b128 a[8:11], v9 offset:53248
    v_max3_f32 v15, v15, v48, v49
    v_max3_f32 v192, v192, v50, v51
    v_mfma_f32_32x32x16_bf16 v[80:95], a[20:23], v[180:183], v[80:95]
L_pad20:
    s_cbranch_execz L_pad21
    ds_read_b128 a[12:15], v10 offset:53248
    v_max3_f32 v15, v15, v52, v53
    v_max3_f32 v192, v192, v54, v55
    s_waitcnt lgkmcnt(4)
    v_mfma_f32_32x32x16_bf16 v[80:95], a[24:27], v[184:187], v[80:95]
    s_and_b32 s31, s37, 0x0
    v_add_u32 v7, s31, v1
    v_add_u32 v8, s31, v2
    v_add_u32 v9, s31, v3
    v_add_u32 v10, s31, v4
    ds_read_b128 a[16:19], v7 offset:57344
    v_max3_f32 v15, v15, v56, v57
    v_max3_f32 v192, v192, v58, v59
    v_mfma_f32_32x32x16_bf16 v[80:95], a[28:31], v[188:191], v[80:95]
    ds_read_b128 a[20:23], v8 offset:57344
    v_max3_f32 v15, v15, v60, v61
    v_max3_f32 v192, v192, v62, v63
    s_waitcnt lgkmcnt(4)
    v_mfma_f32_32x32x16_bf16 v[96:111], a[0:3], v[176:179], v[96:111]
    ds_read_b128 a[24:27], v9 offset:57344
    v_max3_f32 v15, v15, v64, v65
    v_max3_f32 v192, v192, v66, v67
    v_mfma_f32_32x32x16_bf16 v[96:111], a[4:7], v[180:183], v[96:111]
    ds_read_b128 a[28:31], v10 offset:57344
    v_max3_f32 v15, v15, v68, v69
    v_max3_f32 v192, v192, v70, v71
    s_waitcnt lgkmcnt(4)
    v_mfma_f32_32x32x16_bf16 v[96:111], a[8:11], v[184:187], v[96:111]
    s_and_b32 s31, s38, 0x0
    v_add_u32 v7, s31, v1
    v_add_u32 v8, s31, v2
    v_add_u32 v9, s31, v3
    v_add_u32 v10, s31, v4
    ds_read_b128 a[0:3], v7 offset:61440
    v_max3_f32 v15, v15, v72, v73
    v_max3_f32 v192, v192, v74, v75
    v_mfma_f32_32x32x16_bf16 v[96:111], a[12:15], v[188:191], v[96:111]
    ds_read_b128 a[4:7], v8 offset:61440
L_pad21:
    s_cbranch_execz L_pad22
    v_max3_f32 v15, v15, v76, v77
    v_max3_f32 v192, v192, v78, v79
    s_waitcnt lgkmcnt(4)
    v_mfma_f32_32x32x16_bf16 v[112:127], a[16:19], v[176:179], v[112:127]
    ds_read_b128 a[8:11], v9 offset:61440
    v_max3_f32 v15, v15, v80, v81
    v_max3_f32 v192, v192, v82, v83
    v_mfma_f32_32x32x16_bf16 v[112:127], a[20:23], v[180:183], v[112:127]
    ds_read_b128 a[12:15], v10 offset:61440
    v_max3_f32 v15, v15, v84, v85
    v_max3_f32 v192, v192, v86, v87
    s_waitcnt lgkmcnt(4)
    v_mfma_f32_32x32x16_bf16 v[112:127], a[24:27], v[184:187], v[112:127]
    v_add_u32 v7, 65536, v1
    v_add_u32 v8, 65536, v2
    v_add_u32 v9, 65536, v3
    v_add_u32 v10, 65536, v4
    ds_read_b128 a[16:19], v7
    v_max3_f32 v15, v15, v88, v89
    v_max3_f32 v192, v192, v90, v91
    v_mfma_f32_32x32x16_bf16 v[112:127], a[28:31], v[188:191], v[112:127]
    ds_read_b128 a[20:23], v8
    v_max3_f32 v15, v15, v92, v93
    v_max3_f32 v192, v192, v94, v95
    s_waitcnt lgkmcnt(4)
    v_mfma_f32_32x32x16_bf16 v[128:143], a[0:3], v[176:179], v[128:143]
    ds_read_b128 a[24:27], v9
    v_max3_f32 v15, v15, v96, v97
    v_max3_f32 v192, v192, v98, v99
    v_mfma_f32_32x32x16_bf16 v[128:143], a[4:7], v[180:183], v[128:143]
    ds_read_b128 a[28:31], v10
    v_max3_f32 v15, v15, v100, v101
    v_max3_f32 v192, v192, v102, v103
L_pad22:
    s_cbranch_execz L_pad23
    s_waitcnt lgkmcnt(4)
    v_mfma_f32_32x32x16_bf16 v[128:143], a[8:11], v[184:187], v[128:143]
    v_max3_f32 v15, v15, v104, v105
    v_max3_f32 v192, v192, v106, v107
    v_mfma_f32_32x32x16_bf16 v[128:143], a[12:15], v[188:191], v[128:143]
    v_max3_f32 v15, v15, v108, v109
    v_max3_f32 v192, v192, v110, v111
    s_waitcnt lgkmcnt(2)
    v_mfma_f32_32x32x16_bf16 v[144:159], a[16:19], v[176:179], v[144:159]
    v_max3_f32 v15, v15, v112, v113
    v_max3_f32 v192, v192, v114, v115
    v_mfma_f32_32x32x16_bf16 v[144:159], a[20:23], v[180:183], v[144:159]
    v_max3_f32 v15, v15, v116, v117
    v_max3_f32 v192, v192, v118, v119
    s_nop 2
    v_max3_f32 v15, v15, v128, v129
    v_max3_f32 v192, v192, v130, v131
    s_waitcnt lgkmcnt(0)
    v_mfma_f32_32x32x16_bf16 v[144:159], a[24:27], v[184:187], v[144:159]
    v_max3_f32 v15, v15, v120, v121
    v_max3_f32 v192, v192, v122, v123
    v_max3_f32 v15, v15, v132, v133
    v_max3_f32 v192, v192, v134, v135
    v_max3_f32 v15, v15, v136, v137
    v_mfma_f32_32x32x16_bf16 v[144:159], a[28:31], v[188:191], v[144:159]
    v_max3_f32 v15, v15, v124, v125
    v_max3_f32 v192, v192, v126, v127
    v_max3_f32 v192, v192, v138, v139
    v_max3_f32 v15, v15, v140, v141
    v_max3_f32 v192, v192, v142, v143
    s_nop 6
    v_max3_f32 v15, v15, v144, v145
    v_max3_f32 v192, v192, v146, v147
    v_max3_f32 v15, v15, v148, v149
L_pad23:
    s_cbranch_execz L_pad24
    v_max3_f32 v192, v192, v150, v151
    v_max3_f32 v15, v15, v152, v153
    v_max3_f32 v192, v192, v154, v155
    v_max3_f32 v15, v15, v156, v157
    v_max3_f32 v192, v192, v158, v159
    v_max_f32 v15, v15, v192
    v_mov_b32 v192, v15
    s_nop 1
    v_permlane32_swap_b32 v15, v192
    v_max_f32 v15, v15, v192
    v_mul_f32 v193, s54, v15
    v_fma_f32 v16, v16, s54, -v193
    v_fma_f32 v17, v17, s54, -v193
    v_fma_f32 v18, v18, s54, -v193
    v_exp_f32 v16, v16
    v_fma_f32 v19, v19, s54, -v193
    v_exp_f32 v17, v17
    v_fma_f32 v20, v20, s54, -v193
    v_exp_f32 v18, v18
    v_fma_f32 v21, v21, s54, -v193
    v_exp_f32 v19, v19
    v_fma_f32 v22, v22, s54, -v193
    v_cvt_pk_bf16_f32 v16, v16, v17
    v_exp_f32 v20, v20
    v_fma_f32 v23, v23, s54, -v193
    v_exp_f32 v21, v21
    v_fma_f32 v24, v24, s54, -v193
    v_cvt_pk_bf16_f32 v17, v18, v19
    v_exp_f32 v22, v22
    v_fma_f32 v25, v25, s54, -v193
    v_exp_f32 v23, v23
    v_fma_f32 v26, v26, s54, -v193
    v_cvt_pk_bf16_f32 v18, v20, v21
    v_exp_f32 v24, v24
    v_fma_f32 v27, v27, s54, -v193
    v_exp_f32 v25, v25
    v_fma_f32 v28, v28, s54, -v193
    v_cvt_pk_bf16_f32 v19, v22, v23
    v_exp_f32 v26, v26
    v_fma_f32 v29, v29, s54, -v193
L_pad24:
    s_cbranch_execz L_pad25
    v_exp_f32 v27, v27
    v_fma_f32 v30, v30, s54, -v193
    v_cvt_pk_bf16_f32 v20, v24, v25
    v_exp_f32 v28, v28
    v_fma_f32 v31, v31, s54, -v193
    v_exp_f32 v29, v29
    v_cvt_pk_bf16_f32 v21, v26, v27
    v_exp_f32 v30, v30
    v_exp_f32 v31, v31
    v_cvt_pk_bf16_f32 v22, v28, v29
    v_cvt_pk_bf16_f32 v23, v30, v31
    v_mfma_f32_32x32x16_bf16 a[32:47], a[48:51], v[16:19], 0
    v_fma_f32 v32, v32, s54, -v193
    v_fma_f32 v33, v33, s54, -v193
    v_fma_f32 v34, v34, s54, -v193
    v_exp_f32 v32, v32
    v_fma_f32 v35, v35, s54, -v193
    v_exp_f32 v33, v33
    v_fma_f32 v36, v36, s54, -v193
    v_exp_f32 v34, v34
    v_fma_f32 v37, v37, s54, -v193
    v_exp_f32 v35, v35
    v_fma_f32 v38, v38, s54, -v193
    v_cvt_pk_bf16_f32 v24, v32, v33
    v_exp_f32 v36, v36
    v_fma_f32 v39, v39, s54, -v193
    v_exp_f32 v37, v37
    v_fma_f32 v40, v40, s54, -v193
    v_cvt_pk_bf16_f32 v25, v34, v35
    v_exp_f32 v38, v38
    v_fma_f32 v41, v41, s54, -v193
    v_exp_f32 v39, v39
    v_mfma_f32_32x32x16_bf16 a[32:47], a[48:51], v[20:23], a[32:47]
    v_fma_f32 v42, v42, s54, -v193
    v_cvt_pk_bf16_f32 v26, v36, v37
    v_exp_f32 v40, v40
    v_fma_f32 v43, v43, s54, -v193
    v_exp_f32 v41, v41
    v_fma_f32 v44, v44, s54, -v193
L_pad25:
    s_cbranch_execz L_pad26
    v_cvt_pk_bf16_f32 v27, v38, v39
    v_exp_f32 v42, v42
    v_fma_f32 v45, v45, s54, -v193
    v_exp_f32 v43, v43
    v_fma_f32 v46, v46, s54, -v193
    v_cvt_pk_bf16_f32 v28, v40, v41
    v_exp_f32 v44, v44
    v_fma_f32 v47, v47, s54, -v193
    v_exp_f32 v45, v45
    v_cvt_pk_bf16_f32 v29, v42, v43
    v_exp_f32 v46, v46
    v_exp_f32 v47, v47
    v_cvt_pk_bf16_f32 v30, v44, v45
    v_cvt_pk_bf16_f32 v31, v46, v47
    v_mfma_f32_32x32x16_bf16 a[32:47], a[48:51], v[24:27], a[32:47]
    s_barrier
    ds_read_b64_tr_b16 a[0:1], v5
    ds_read_b64_tr_b16 a[2:3], v5 offset:1024
    ds_read_b64_tr_b16 a[4:5], v6
    ds_read_b64_tr_b16 a[6:7], v6 offset:1024
    v_fma_f32 v48, v48, s54, -v193
    v_fma_f32 v49, v49, s54, -v193
    v_fma_f32 v50, v50, s54, -v193
    v_exp_f32 v48, v48
    v_fma_f32 v51, v51, s54, -v193
    v_exp_f32 v49, v49
    v_fma_f32 v52, v52, s54, -v193
    v_exp_f32 v50, v50
    v_fma_f32 v53, v53, s54, -v193
    v_exp_f32 v51, v51
    v_fma_f32 v54, v54, s54, -v193
    v_cvt_pk_bf16_f32 v32, v48, v49
    v_exp_f32 v52, v52
    v_fma_f32 v55, v55, s54, -v193
    v_exp_f32 v53, v53
    v_fma_f32 v56, v56, s54, -v193
    v_cvt_pk_bf16_f32 v33, v50, v51
    v_exp_f32 v54, v54
    v_fma_f32 v57, v57, s54, -v193
L_pad26:
    s_cbranch_execz L_pad27
    v_exp_f32 v55, v55
    v_mfma_f32_32x32x16_bf16 a[32:47], a[48:51], v[28:31], a[32:47]
    ds_read_b64_tr_b16 a[8:9], v5 offset:2048
    ds_read_b64_tr_b16 a[10:11], v5 offset:3072
    ds_read_b64_tr_b16 a[12:13], v6 offset:2048
    ds_read_b64_tr_b16 a[14:15], v6 offset:3072
    v_fma_f32 v58, v58, s54, -v193
    v_cvt_pk_bf16_f32 v34, v52, v53
    v_exp_f32 v56, v56
    v_fma_f32 v59, v59, s54, -v193
    v_exp_f32 v57, v57
    v_fma_f32 v60, v60, s54, -v193
    v_cvt_pk_bf16_f32 v35, v54, v55
    v_exp_f32 v58, v58
    v_fma_f32 v61, v61, s54, -v193
    v_exp_f32 v59, v59
    v_fma_f32 v62, v62, s54, -v193
    v_cvt_pk_bf16_f32 v36, v56, v57
    v_exp_f32 v60, v60
    v_fma_f32 v63, v63, s54, -v193
    v_exp_f32 v61, v61
    v_cvt_pk_bf16_f32 v37, v58, v59
    v_exp_f32 v62, v62
    v_exp_f32 v63, v63
    v_cvt_pk_bf16_f32 v38, v60, v61
    v_cvt_pk_bf16_f32 v39, v62, v63
    v_mfma_f32_32x32x16_bf16 a[32:47], a[48:51], v[32:35], a[32:47]
    ds_read_b64_tr_b16 a[16:17], v5 offset:4096
    ds_read_b64_tr_b16 a[18:19], v5 offset:5120
    v_fma_f32 v64, v64, s54, -v193
    v_fma_f32 v65, v65, s54, -v193
    v_fma_f32 v66, v66, s54, -v193
    v_exp_f32 v64, v64
    v_fma_f32 v67, v67, s54, -v193
    s_waitcnt lgkmcnt(6)
    v_mfma_f32_32x32x16_bf16 v[160:175], a[0:3], v[16:19], 0
    ds_read_b64_tr_b16 a[20:21], v6 offset:4096
L_pad27:
    s_cbranch_execz L_pad28
    ds_read_b64_tr_b16 a[22:23], v6 offset:5120
    v_exp_f32 v65, v65
    v_fma_f32 v68, v68, s54, -v193
    v_exp_f32 v66, v66
    v_mfma_f32_32x32x16_bf16 v[176:191], a[4:7], v[16:19], 0
    ds_read_b64_tr_b16 a[24:25], v5 offset:6144
    ds_read_b64_tr_b16 a[26:27], v5 offset:7168
    v_fma_f32 v69, v69, s54, -v193
    v_exp_f32 v67, v67
    v_fma_f32 v70, v70, s54, -v193
    v_cvt_pk_bf16_f32 v40, v64, v65
    s_waitcnt lgkmcnt(6)
    v_mfma_f32_32x32x16_bf16 v[160:175], a[8:11], v[20:23], v[160:175]
    ds_read_b64_tr_b16 a[28:29], v6 offset:6144
    ds_read_b64_tr_b16 a[30:31], v6 offset:7168
    v_exp_f32 v68, v68
    v_fma_f32 v71, v71, s54, -v193
    v_exp_f32 v69, v69
    v_fma_f32 v72, v72, s54, -v193
    v_mfma_f32_32x32x16_bf16 v[176:191], a[12:15], v[20:23], v[176:191]
    v_cvt_pk_bf16_f32 v41, v66, v67
    v_exp_f32 v70, v70
    v_fma_f32 v73, v73, s54, -v193
    v_exp_f32 v71, v71
    v_mfma_f32_32x32x16_bf16 a[32:47], a[48:51], v[36:39], a[32:47]
    ds_read_b64_tr_b16 a[0:1], v5 offset:8192
    ds_read_b64_tr_b16 a[2:3], v5 offset:9216
    v_fma_f32 v74, v74, s54, -v193
    v_cvt_pk_bf16_f32 v42, v68, v69
    v_exp_f32 v72, v72
    v_fma_f32 v75, v75, s54, -v193
    s_waitcnt lgkmcnt(6)
    v_mfma_f32_32x32x16_bf16 v[160:175], a[16:19], v[24:27], v[160:175]
    ds_read_b64_tr_b16 a[4:5], v6 offset:8192
    ds_read_b64_tr_b16 a[6:7], v6 offset:9216
    v_exp_f32 v73, v73
    v_fma_f32 v76, v76, s54, -v193
L_pad28:
    s_cbranch_execz L_pad29
    v_cvt_pk_bf16_f32 v43, v70, v71
    v_exp_f32 v74, v74
    v_mfma_f32_32x32x16_bf16 v[176:191], a[20:23], v[24:27], v[176:191]
    ds_read_b64_tr_b16 a[8:9], v5 offset:10240
    ds_read_b64_tr_b16 a[10:11], v5 offset:11264
    v_fma_f32 v77, v77, s54, -v193
    v_exp_f32 v75, v75
    v_fma_f32 v78, v78, s54, -v193
    v_cvt_pk_bf16_f32 v44, v72, v73
    s_waitcnt lgkmcnt(6)
    v_mfma_f32_32x32x16_bf16 v[160:175], a[24:27], v[28:31], v[160:175]
    ds_read_b64_tr_b16 a[12:13], v6 offset:10240
    ds_read_b64_tr_b16 a[14:15], v6 offset:11264
    v_exp_f32 v76, v76
    v_fma_f32 v79, v79, s54, -v193
    v_exp_f32 v77, v77
    v_cvt_pk_bf16_f32 v45, v74, v75
    v_mfma_f32_32x32x16_bf16 v[176:191], a[28:31], v[28:31], v[176:191]
    v_exp_f32 v78, v78
    v_exp_f32 v79, v79
    v_cvt_pk_bf16_f32 v46, v76, v77
    v_cvt_pk_bf16_f32 v47, v78, v79
    v_mfma_f32_32x32x16_bf16 a[32:47], a[48:51], v[40:43], a[32:47]
    ds_read_b64_tr_b16 a[16:17], v5 offset:12288
    ds_read_b64_tr_b16 a[18:19], v5 offset:13312
    v_fma_f32 v80, v80, s54, -v193
    v_fma_f32 v81, v81, s54, -v193
    v_fma_f32 v82, v82, s54, -v193
    v_exp_f32 v80, v80
    v_fma_f32 v83, v83, s54, -v193
    s_waitcnt lgkmcnt(6)
    v_mfma_f32_32x32x16_bf16 v[160:175], a[0:3], v[32:35], v[160:175]
    ds_read_b64_tr_b16 a[20:21], v6 offset:12288
    ds_read_b64_tr_b16 a[22:23], v6 offset:13312
    v_exp_f32 v81, v81
    v_fma_f32 v84, v84, s54, -v193
    v_exp_f32 v82, v82
L_pad29:
    s_cbranch_execz L_hopdone
    v_mfma_f32_32x32x16_bf16 v[176:191], a[4:7], v[32:35], v[176:191]
    ds_read_b64_tr_b16 a[24:25], v5 offset:14336
    ds_read_b64_tr_b16 a[26:27], v5 offset:15360
    v_fma_f32 v85, v85, s54, -v193
    v_exp_f32 v83, v83
    v_fma_f32 v86, v86, s54, -v193
    v_cvt_pk_bf16_f32 v48, v80, v81
    s_waitcnt lgkmcnt(6)
    v_mfma_f32_32x32x16_bf16 v[160:175], a[8:11], v[36:39], v[160:175]
    ds_read_b64_tr_b16 a[28:29], v6 offset:14336
    ds_read_b64_tr_b16 a[30:31], v6 offset:15360
    v_exp_f32 v84, v84
    v_fma_f32 v87, v87, s54, -v193
    v_exp_f32 v85, v85
    v_fma_f32 v88, v88, s54, -v193
    v_mfma_f32_32x32x16_bf16 v[176:191], a[12:15], v[36:39], v[176:191]
    v_cvt_pk_bf16_f32 v49, v82, v83
    v_exp_f32 v86, v86
    v_fma_f32 v89, v89, s54, -v193
    v_exp_f32 v87, v87
    v_mfma_f32_32x32x16_bf16 a[32:47], a[48:51], v[44:47], a[32:47]
    ds_read_b64_tr_b16 a[0:1], v5 offset:16384
    ds_read_b64_tr_b16 a[2:3], v5 offset:17408
    v_fma_f32 v90, v90, s54, -v193
    v_cvt_pk_bf16_f32 v50, v84, v85
    v_exp_f32 v88, v88
    v_fma_f32 v91, v91, s54, -v193
    s_waitcnt lgkmcnt(6)
    v_mfma_f32_32x32x16_bf16 v[160:175], a[16:19], v[40:43], v[160:175]
    ds_read_b64_tr_b16 a[4:5], v6 offset:16384
    ds_read_b64_tr_b16 a[6:7], v6 offset:17408
    v_exp_f32 v89, v89
    v_fma_f32 v92, v92, s54, -v193
    v_cvt_pk_bf16_f32 v51, v86, v87
    v_exp_f32 v90, v90
    v_mfma_f32_32x32x16_bf16 v[176:191], a[20:23], v[40:43], v[176:191]
    v_fma_f32 v93, v93, s54, -v193
L_pad30:
    s_cbranch_execz L_pad31
    v_exp_f32 v91, v91
    v_fma_f32 v94, v94, s54, -v193
    v_cvt_pk_bf16_f32 v52, v88, v89
    s_waitcnt lgkmcnt(4)
    v_mfma_f32_32x32x16_bf16 v[160:175], a[24:27], v[44:47], v[160:175]
    ds_read_b64_tr_b16 a[8:9], v5 offset:18432
    ds_read_b64_tr_b16 a[10:11], v5 offset:19456
    v_exp_f32 v92, v92
    v_fma_f32 v95, v95, s54, -v193
    v_exp_f32 v93, v93
    v_cvt_pk_bf16_f32 v53, v90, v91
    v_mfma_f32_32x32x16_bf16 v[176:191], a[28:31], v[44:47], v[176:191]
    ds_read_b64_tr_b16 a[12:13], v6 offset:18432
    ds_read_b64_tr_b16 a[14:15], v6 offset:19456
    v_exp_f32 v94, v94
    v_exp_f32 v95, v95
    v_cvt_pk_bf16_f32 v54, v92, v93
    v_cvt_pk_bf16_f32 v55, v94, v95
    v_mfma_f32_32x32x16_bf16 a[32:47], a[48:51], v[48:51], a[32:47]
    v_fma_f32 v96, v96, s54, -v193
    v_fma_f32 v97, v97, s54, -v193
    v_fma_f32 v98, v98, s54, -v193
    v_exp_f32 v96, v96
    v_fma_f32 v99, v99, s54, -v193
    v_exp_f32 v97, v97
    v_fma_f32 v100, v100, s54, -v193
    s_waitcnt lgkmcnt(4)
    v_mfma_f32_32x32x16_bf16 v[160:175], a[0:3], v[48:51], v[160:175]
    s_and_b32 s31, s36, 0x10000
    v_add_u32 v7, s31, v5
    v_add_u32 v8, s31, v6
    ds_read_b64_tr_b16 a[16:17], v7 offset:20480
    ds_read_b64_tr_b16 a[18:19], v7 offset:21504
    v_exp_f32 v98, v98
    v_fma_f32 v101, v101, s54, -v193
    v_exp_f32 v99, v99
    v_fma_f32 v102, v102, s54, -v193
    v_cvt_pk_bf16_f32 v56, v96, v97
L_pad31:
    s_cbranch_execz L_pad32
    v_exp_f32 v100, v100
    v_fma_f32 v103, v103, s54, -v193
    v_mfma_f32_32x32x16_bf16 v[176:191], a[4:7], v[48:51], v[176:191]
    ds_read_b64_tr_b16 a[20:21], v8 offset:20480
    ds_read_b64_tr_b16 a[22:23], v8 offset:21504
    v_exp_f32 v101, v101
    v_fma_f32 v104, v104, s54, -v193
    v_cvt_pk_bf16_f32 v57, v98, v99
    v_exp_f32 v102, v102
    v_fma_f32 v105, v105, s54, -v193
    v_exp_f32 v103, v103
    v_mfma_f32_32x32x16_bf16 a[32:47], a[48:51], v[52:55], a[32:47]
    v_fma_f32 v106, v106, s54, -v193
    v_cvt_pk_bf16_f32 v58, v100, v101
    v_exp_f32 v104, v104
    v_fma_f32 v107, v107, s54, -v193
    v_exp_f32 v105, v105
    v_fma_f32 v108, v108, s54, -v193
    v_cvt_pk_bf16_f32 v59, v102, v103
    s_waitcnt lgkmcnt(4)
    v_mfma_f32_32x32x16_bf16 v[160:175], a[8:11], v[52:55], v[160:175]
    ds_read_b64_tr_b16 a[24:25], v7 offset:22528
    ds_read_b64_tr_b16 a[26:27], v7 offset:23552
    v_exp_f32 v106, v106
    v_fma_f32 v109, v109, s54, -v193
    v_exp_f32 v107, v107
    v_fma_f32 v110, v110, s54, -v193
    v_cvt_pk_bf16_f32 v60, v104, v105
    v_exp_f32 v108, v108
    v_fma_f32 v111, v111, s54, -v193
    v_mfma_f32_32x32x16_bf16 v[176:191], a[12:15], v[52:55], v[176:191]
    ds_read_b64_tr_b16 a[28:29], v8 offset:22528
    ds_read_b64_tr_b16 a[30:31], v8 offset:23552
    v_exp_f32 v109, v109
    v_cvt_pk_bf16_f32 v61, v106, v107
    v_exp_f32 v110, v110
    v_exp_f32 v111, v111
    v_cvt_pk_bf16_f32 v62, v108, v109
L_pad32:
    s_cbranch_execz L_pad33
    v_cvt_pk_bf16_f32 v63, v110, v111
    v_mfma_f32_32x32x16_bf16 a[32:47], a[48:51], v[56:59], a[32:47]
    v_fma_f32 v112, v112, s54, -v193
    v_fma_f32 v113, v113, s54, -v193
    v_fma_f32 v114, v114, s54, -v193
    v_exp_f32 v112, v112
    v_fma_f32 v115, v115, s54, -v193
    v_exp_f32 v113, v113
    v_fma_f32 v116, v116, s54, -v193
    s_waitcnt lgkmcnt(4)
    v_mfma_f32_32x32x16_bf16 v[160:175], a[16:19], v[56:59], v[160:175]
    s_and_b32 s31, s37, 0x10000
    v_add_u32 v7, s31, v5
    v_add_u32 v8, s31, v6
    ds_read_b64_tr_b16 a[0:1], v7 offset:24576
    ds_read_b64_tr_b16 a[2:3], v7 offset:25600
    v_exp_f32 v114, v114
    v_fma_f32 v117, v117, s54, -v193
    v_exp_f32 v115, v115
    v_fma_f32 v118, v118, s54, -v193
    v_cvt_pk_bf16_f32 v64, v112, v113
    v_exp_f32 v116, v116
    v_fma_f32 v119, v119, s54, -v193
    v_mfma_f32_32x32x16_bf16 v[176:191], a[20:23], v[56:59], v[176:191]
    ds_read_b64_tr_b16 a[4:5], v8 offset:24576
    ds_read_b64_tr_b16 a[6:7], v8 offset:25600
    v_exp_f32 v117, v117
    v_fma_f32 v120, v120, s54, -v193
    v_cvt_pk_bf16_f32 v65, v114, v115
    v_exp_f32 v118, v118
    v_fma_f32 v121, v121, s54, -v193
    v_exp_f32 v119, v119
    v_mfma_f32_32x32x16_bf16 a[32:47], a[48:51], v[60:63], a[32:47]
    v_fma_f32 v122, v122, s54, -v193
    v_cvt_pk_bf16_f32 v66, v116, v117
    v_exp_f32 v120, v120
    v_fma_f32 v123, v123, s54, -v193
    v_exp_f32 v121, v121
L_pad33:
    s_cbranch_execz L_pad34
    v_fma_f32 v124, v124, s54, -v193
    v_cvt_pk_bf16_f32 v67, v118, v119
    s_waitcnt lgkmcnt(4)
    v_mfma_f32_32x32x16_bf16 v[160:175], a[24:27], v[60:63], v[160:175]
    ds_read_b64_tr_b16 a[8:9], v7 offset:26624
    ds_read_b64_tr_b16 a[10:11], v7 offset:27648
    v_exp_f32 v122, v122
    v_fma_f32 v125, v125, s54, -v193
    v_exp_f32 v123, v123
    v_fma_f32 v126, v126, s54, -v193
    v_cvt_pk_bf16_f32 v68, v120, v121
    v_exp_f32 v124, v124
    v_fma_f32 v127, v127, s54, -v193
    v_mfma_f32_32x32x16_bf16 v[176:191], a[28:31], v[60:63], v[176:191]
    ds_read_b64_tr_b16 a[12:13], v8 offset:26624
    ds_read_b64_tr_b16 a[14:15], v8 offset:27648
    v_exp_f32 v125, v125
    v_cvt_pk_bf16_f32 v69, v122, v123
    v_exp_f32 v126, v126
    v_exp_f32 v127, v127
    v_cvt_pk_bf16_f32 v70, v124, v125
    v_cvt_pk_bf16_f32 v71, v126, v127
    v_mfma_f32_32x32x16_bf16 a[32:47], a[48:51], v[64:67], a[32:47]
    v_fma_f32 v128, v128, s54, -v193
    v_fma_f32 v129, v129, s54, -v193
    v_fma_f32 v130, v130, s54, -v193
    v_exp_f32 v128, v128
    v_fma_f32 v131, v131, s54, -v193
    v_exp_f32 v129, v129
    v_fma_f32 v132, v132, s54, -v193
    s_waitcnt lgkmcnt(4)
    v_mfma_f32_32x32x16_bf16 v[160:175], a[0:3], v[64:67], v[160:175]
    s_and_b32 s31, s38, 0x10000
    v_add_u32 v7, s31, v5
    v_add_u32 v8, s31, v6
    ds_read_b64_tr_b16 a[16:17], v7 offset:28672
    ds_read_b64_tr_b16 a[18:19], v7 offset:29696
    v_exp_f32 v130, v130
L_pad34:
    s_cbranch_execz L_pad35
    v_fma_f32 v133, v133, s54, -v193
    v_exp_f32 v131, v131
    v_fma_f32 v134, v134, s54, -v193
    v_cvt_pk_bf16_f32 v72, v128, v129
    v_exp_f32 v132, v132
    v_fma_f32 v135, v135, s54, -v193
    v_mfma_f32_32x32x16_bf16 v[176:191], a[4:7], v[64:67], v[176:191]
    ds_read_b64_tr_b16 a[20:21], v8 offset:28672
    ds_read_b64_tr_b16 a[22:23], v8 offset:29696
    v_exp_f32 v133, v133
    v_fma_f32 v136, v136, s54, -v193
    v_cvt_pk_bf16_f32 v73, v130, v131
    v_exp_f32 v134, v134
    v_fma_f32 v137, v137, s54, -v193
    v_exp_f32 v135, v135
    v_mfma_f32_32x32x16_bf16 a[32:47], a[48:51], v[68:71], a[32:47]
    v_fma_f32 v138, v138, s54, -v193
    v_cvt_pk_bf16_f32 v74, v132, v133
    v_exp_f32 v136, v136
    v_fma_f32 v139, v139, s54, -v193
    v_exp_f32 v137, v137
    v_fma_f32 v140, v140, s54, -v193
    v_cvt_pk_bf16_f32 v75, v134, v135
    s_waitcnt lgkmcnt(4)
    v_mfma_f32_32x32x16_bf16 v[160:175], a[8:11], v[68:71], v[160:175]
    ds_read_b64_tr_b16 a[24:25], v7 offset:30720
    ds_read_b64_tr_b16 a[26:27], v7 offset:31744
    v_exp_f32 v138, v138
    v_fma_f32 v141, v141, s54, -v193
    v_exp_f32 v139, v139
    v_fma_f32 v142, v142, s54, -v193
    v_cvt_pk_bf16_f32 v76, v136, v137
    v_exp_f32 v140, v140
    v_fma_f32 v143, v143, s54, -v193
    v_mfma_f32_32x32x16_bf16 v[176:191], a[12:15], v[68:71], v[176:191]
    ds_read_b64_tr_b16 a[28:29], v8 offset:30720
    ds_read_b64_tr_b16 a[30:31], v8 offset:31744
L_pad35:
    s_cbranch_execz L_pad36
    v_exp_f32 v141, v141
    v_cvt_pk_bf16_f32 v77, v138, v139
    v_exp_f32 v142, v142
    v_exp_f32 v143, v143
    v_cvt_pk_bf16_f32 v78, v140, v141
    v_cvt_pk_bf16_f32 v79, v142, v143
    v_mfma_f32_32x32x16_bf16 a[32:47], a[48:51], v[72:75], a[32:47]
    v_fma_f32 v144, v144, s54, -v193
    v_fma_f32 v145, v145, s54, -v193
    v_fma_f32 v146, v146, s54, -v193
    v_exp_f32 v144, v144
    v_fma_f32 v147, v147, s54, -v193
    v_exp_f32 v145, v145
    v_fma_f32 v148, v148, s54, -v193
    s_waitcnt lgkmcnt(4)
    v_mfma_f32_32x32x16_bf16 v[160:175], a[16:19], v[72:75], v[160:175]
    v_add_u32 v7, 98304, v5
    v_add_u32 v8, 98304, v6
    ds_read_b64_tr_b16 a[0:1], v7
    ds_read_b64_tr_b16 a[2:3], v7 offset:1024
    v_exp_f32 v146, v146
    v_fma_f32 v149, v149, s54, -v193
    v_exp_f32 v147, v147
    v_fma_f32 v150, v150, s54, -v193
    v_cvt_pk_bf16_f32 v80, v144, v145
    v_exp_f32 v148, v148
    v_fma_f32 v151, v151, s54, -v193
    v_mfma_f32_32x32x16_bf16 v[176:191], a[20:23], v[72:75], v[176:191]
    ds_read_b64_tr_b16 a[4:5], v8
    ds_read_b64_tr_b16 a[6:7], v8 offset:1024
    v_exp_f32 v149, v149
    v_fma_f32 v152, v152, s54, -v193
    v_cvt_pk_bf16_f32 v81, v146, v147
    v_exp_f32 v150, v150
    v_fma_f32 v153, v153, s54, -v193
    v_exp_f32 v151, v151
    v_mfma_f32_32x32x16_bf16 a[32:47], a[48:51], v[76:79], a[32:47]
    v_fma_f32 v154, v154, s54, -v193
L_pad36:
    s_cbranch_execz L_pad37
    v_cvt_pk_bf16_f32 v82, v148, v149
    v_exp_f32 v152, v152
    v_fma_f32 v155, v155, s54, -v193
    v_exp_f32 v153, v153
    v_fma_f32 v156, v156, s54, -v193
    v_cvt_pk_bf16_f32 v83, v150, v151
    s_waitcnt lgkmcnt(4)
    v_mfma_f32_32x32x16_bf16 v[160:175], a[24:27], v[76:79], v[160:175]
    ds_read_b64_tr_b16 a[8:9], v7 offset:2048
    ds_read_b64_tr_b16 a[10:11], v7 offset:3072
    v_exp_f32 v154, v154
    v_fma_f32 v157, v157, s54, -v193
    v_exp_f32 v155, v155
    v_fma_f32 v158, v158, s54, -v193
    v_cvt_pk_bf16_f32 v84, v152, v153
    v_exp_f32 v156, v156
    v_fma_f32 v159, v159, s54, -v193
    v_mfma_f32_32x32x16_bf16 v[176:191], a[28:31], v[76:79], v[176:191]
    ds_read_b64_tr_b16 a[12:13], v8 offset:2048
    ds_read_b64_tr_b16 a[14:15], v8 offset:3072
    v_exp_f32 v157, v157
    v_cvt_pk_bf16_f32 v85, v154, v155
    v_exp_f32 v158, v158
    v_exp_f32 v159, v159
    v_cvt_pk_bf16_f32 v86, v156, v157
    v_cvt_pk_bf16_f32 v87, v158, v159
    v_mfma_f32_32x32x16_bf16 a[32:47], a[48:51], v[80:83], a[32:47]
    s_waitcnt lgkmcnt(4)
    v_mfma_f32_32x32x16_bf16 v[160:175], a[0:3], v[80:83], v[160:175]
    v_mfma_f32_32x32x16_bf16 v[176:191], a[4:7], v[80:83], v[176:191]
    v_mfma_f32_32x32x16_bf16 a[32:47], a[48:51], v[84:87], a[32:47]
    s_waitcnt lgkmcnt(0)
    s_barrier
    ds_read_b64_tr_b16 a[16:17], v5 offset:32768
    ds_read_b64_tr_b16 a[18:19], v5 offset:33792
    ds_read_b64_tr_b16 a[20:21], v5 offset:34816
    ds_read_b64_tr_b16 a[22:23], v5 offset:35840
    v_mfma_f32_32x32x16_bf16 v[160:175], a[8:11], v[84:87], v[160:175]
L_pad37:
    s_cbranch_execz L_pad38
    ds_read_b64_tr_b16 a[24:25], v5 offset:36864
    ds_read_b64_tr_b16 a[26:27], v5 offset:37888
    ds_read_b64_tr_b16 a[28:29], v5 offset:38912
    ds_read_b64_tr_b16 a[30:31], v5 offset:39936
    v_mfma_f32_32x32x16_bf16 v[176:191], a[12:15], v[84:87], v[176:191]
    ds_read_b64_tr_b16 a[0:1], v5 offset:40960
    ds_read_b64_tr_b16 a[2:3], v5 offset:41984
    ds_read_b64_tr_b16 a[4:5], v5 offset:43008
    ds_read_b64_tr_b16 a[6:7], v5 offset:44032
    s_waitcnt lgkmcnt(8)
    v_mfma_f32_32x32x16_bf16 v[96:111], a[16:19], v[16:19], 0
    ds_read_b64_tr_b16 a[8:9], v5 offset:45056
    ds_read_b64_tr_b16 a[10:11], v5 offset:46080
    v_mfma_f32_32x32x16_bf16 v[96:111], a[20:23], v[20:23], v[96:111]
    ds_read_b64_tr_b16 a[12:13], v5 offset:47104
    ds_read_b64_tr_b16 a[14:15], v5 offset:48128
    s_waitcnt lgkmcnt(8)
    v_mfma_f32_32x32x16_bf16 v[96:111], a[24:27], v[24:27], v[96:111]
    ds_read_b64_tr_b16 a[16:17], v5 offset:49152
    ds_read_b64_tr_b16 a[18:19], v5 offset:50176
    v_accvgpr_read_b32 v194, a32
    v_rcp_f32 v194, v194
    s_add_u32 s24, s40, s48
    s_addc_u32 s25, s41, 0
    v_mul_f32 v160, v160, v194
    v_mul_f32 v161, v161, v194
    v_mul_f32 v162, v162, v194
    v_mfma_f32_32x32x16_bf16 v[96:111], a[28:31], v[28:31], v[96:111]
    ds_read_b64_tr_b16 a[20:21], v5 offset:51200
    ds_read_b64_tr_b16 a[22:23], v5 offset:52224
    v_mul_f32 v163, v163, v194
    v_cvt_pk_bf16_f32 v160, v160, v161
    v_mul_f32 v164, v164, v194
    v_mul_f32 v165, v165, v194
    s_waitcnt lgkmcnt(8)
    v_mfma_f32_32x32x16_bf16 v[96:111], a[0:3], v[32:35], v[96:111]
    s_and_b32 s31, s36, 0xc000
    v_add_u32 v7, s31, v5
L_pad38:
    s_cbranch_execz L_pad39
    ds_read_b64_tr_b16 a[24:25], v7 offset:53248
    ds_read_b64_tr_b16 a[26:27], v7 offset:54272
    v_cvt_pk_bf16_f32 v161, v162, v163
    v_mul_f32 v166, v166, v194
    v_mul_f32 v167, v167, v194
    v_cvt_pk_bf16_f32 v162, v164, v165
    v_mfma_f32_32x32x16_bf16 v[96:111], a[4:7], v[36:39], v[96:111]
    ds_read_b64_tr_b16 a[28:29], v7 offset:55296
    ds_read_b64_tr_b16 a[30:31], v7 offset:56320
    v_mul_f32 v168, v168, v194
    v_mul_f32 v169, v169, v194
    v_cvt_pk_bf16_f32 v163, v166, v167
    v_mul_f32 v170, v170, v194
    s_waitcnt lgkmcnt(8)
    v_mfma_f32_32x32x16_bf16 v[96:111], a[8:11], v[40:43], v[96:111]
    s_and_b32 s31, s37, 0xc000
    v_add_u32 v7, s31, v5
    ds_read_b64_tr_b16 a[0:1], v7 offset:57344
    ds_read_b64_tr_b16 a[2:3], v7 offset:58368
    v_mul_f32 v171, v171, v194
    v_cvt_pk_bf16_f32 v164, v168, v169
    v_mul_f32 v172, v172, v194
    v_mul_f32 v173, v173, v194
    v_mfma_f32_32x32x16_bf16 v[96:111], a[12:15], v[44:47], v[96:111]
    ds_read_b64_tr_b16 a[4:5], v7 offset:59392
    ds_read_b64_tr_b16 a[6:7], v7 offset:60416
    v_cvt_pk_bf16_f32 v165, v170, v171
    v_mul_f32 v174, v174, v194
    v_mul_f32 v175, v175, v194
    v_cvt_pk_bf16_f32 v166, v172, v173
    s_waitcnt lgkmcnt(8)
    v_mfma_f32_32x32x16_bf16 v[96:111], a[16:19], v[48:51], v[96:111]
    s_and_b32 s31, s38, 0xc000
    v_add_u32 v7, s31, v5
    ds_read_b64_tr_b16 a[8:9], v7 offset:61440
    ds_read_b64_tr_b16 a[10:11], v7 offset:62464
    v_cvt_pk_bf16_f32 v167, v174, v175
    v_permlane16_swap_b32 v160, v164
    v_mfma_f32_32x32x16_bf16 v[96:111], a[20:23], v[52:55], v[96:111]
L_pad39:
    s_cbranch_execz L_pad40
    ds_read_b64_tr_b16 a[12:13], v7 offset:63488
    ds_read_b64_tr_b16 a[14:15], v7 offset:64512
    v_permlane16_swap_b32 v161, v165
    v_permlane16_swap_b32 v162, v166
    s_waitcnt lgkmcnt(8)
    v_mfma_f32_32x32x16_bf16 v[96:111], a[24:27], v[56:59], v[96:111]
    v_add_u32 v7, 114688, v5
    ds_read_b64_tr_b16 a[16:17], v7
    ds_read_b64_tr_b16 a[18:19], v7 offset:1024
    v_permlane16_swap_b32 v163, v167
    v_mul_f32 v176, v176, v194
    v_mul_f32 v177, v177, v194
    v_mul_f32 v178, v178, v194
    v_mfma_f32_32x32x16_bf16 v[96:111], a[28:31], v[60:63], v[96:111]
    ds_read_b64_tr_b16 a[20:21], v7 offset:2048
    ds_read_b64_tr_b16 a[22:23], v7 offset:3072
    v_mul_f32 v179, v179, v194
    v_cvt_pk_bf16_f32 v176, v176, v177
    v_mul_f32 v180, v180, v194
    v_mul_f32 v181, v181, v194
    s_waitcnt lgkmcnt(8)
    v_mfma_f32_32x32x16_bf16 v[96:111], a[0:3], v[64:67], v[96:111]
    ds_read_b64_tr_b16 a[24:25], v6 offset:32768
    ds_read_b64_tr_b16 a[26:27], v6 offset:33792
    v_cvt_pk_bf16_f32 v177, v178, v179
    v_mul_f32 v182, v182, v194
    v_mul_f32 v183, v183, v194
    v_cvt_pk_bf16_f32 v178, v180, v181
    v_mfma_f32_32x32x16_bf16 v[96:111], a[4:7], v[68:71], v[96:111]
    ds_read_b64_tr_b16 a[28:29], v6 offset:34816
    ds_read_b64_tr_b16 a[30:31], v6 offset:35840
    v_mul_f32 v184, v184, v194
    v_mul_f32 v185, v185, v194
    v_cvt_pk_bf16_f32 v179, v182, v183
    v_mul_f32 v186, v186, v194
    s_waitcnt lgkmcnt(8)
    v_mfma_f32_32x32x16_bf16 v[96:111], a[8:11], v[72:75], v[96:111]
    ds_read_b64_tr_b16 a[0:1], v6 offset:36864
    ds_read_b64_tr_b16 a[2:3], v6 offset:37888
    v_mul_f32 v187, v187, v194
    v_cvt_pk_bf16_f32 v180, v184, v185
L_pad40:
    s_cbranch_execz L_pad41
    v_mul_f32 v188, v188, v194
    v_mul_f32 v189, v189, v194
    v_mfma_f32_32x32x16_bf16 v[96:111], a[12:15], v[76:79], v[96:111]
    ds_read_b64_tr_b16 a[4:5], v6 offset:38912
    ds_read_b64_tr_b16 a[6:7], v6 offset:39936
    v_cvt_pk_bf16_f32 v181, v186, v187
    v_mul_f32 v190, v190, v194
    v_mul_f32 v191, v191, v194
    v_cvt_pk_bf16_f32 v182, v188, v189
    s_waitcnt lgkmcnt(8)
    v_mfma_f32_32x32x16_bf16 v[96:111], a[16:19], v[80:83], v[96:111]
    ds_read_b64_tr_b16 a[8:9], v6 offset:40960
    ds_read_b64_tr_b16 a[10:11], v6 offset:41984
    v_cvt_pk_bf16_f32 v183, v190, v191
    v_permlane16_swap_b32 v176, v180
    v_mfma_f32_32x32x16_bf16 v[96:111], a[20:23], v[84:87], v[96:111]
    ds_read_b64_tr_b16 a[12:13], v6 offset:43008
    ds_read_b64_tr_b16 a[14:15], v6 offset:44032
    v_permlane16_swap_b32 v177, v181
    v_permlane16_swap_b32 v178, v182
    s_waitcnt lgkmcnt(8)
    v_mfma_f32_32x32x16_bf16 v[112:127], a[24:27], v[16:19], 0
    ds_read_b64_tr_b16 a[16:17], v6 offset:45056
    ds_read_b64_tr_b16 a[18:19], v6 offset:46080
    v_permlane16_swap_b32 v179, v183
    s_mov_b32 vcc_lo, 0x00ff00ff
    s_mov_b32 vcc_hi, 0x00ff00ff
    v_cndmask_b32_dpp v168, v176, v160, vcc row_ror:8 row_mask:0xf bank_mask:0xf
    v_mfma_f32_32x32x16_bf16 v[112:127], a[28:31], v[20:23], v[112:127]
    ds_read_b64_tr_b16 a[20:21], v6 offset:47104
    ds_read_b64_tr_b16 a[22:23], v6 offset:48128
    v_cndmask_b32_dpp v169, v177, v161, vcc row_ror:8 row_mask:0xf bank_mask:0xf
    v_cndmask_b32_dpp v170, v178, v162, vcc row_ror:8 row_mask:0xf bank_mask:0xf
    v_cndmask_b32_dpp v171, v179, v163, vcc row_ror:8 row_mask:0xf bank_mask:0xf
    v_cndmask_b32_dpp v172, v180, v164, vcc row_ror:8 row_mask:0xf bank_mask:0xf
    s_waitcnt lgkmcnt(8)
    v_mfma_f32_32x32x16_bf16 v[112:127], a[0:3], v[24:27], v[112:127]
L_pad41:
    s_cbranch_execz L_pad42
    ds_read_b64_tr_b16 a[24:25], v6 offset:49152
    ds_read_b64_tr_b16 a[26:27], v6 offset:50176
    v_cndmask_b32_dpp v173, v181, v165, vcc row_ror:8 row_mask:0xf bank_mask:0xf
    v_cndmask_b32_dpp v174, v182, v166, vcc row_ror:8 row_mask:0xf bank_mask:0xf
    v_cndmask_b32_dpp v175, v183, v167, vcc row_ror:8 row_mask:0xf bank_mask:0xf
    v_mfma_f32_32x32x16_bf16 v[112:127], a[4:7], v[28:31], v[112:127]
    ds_read_b64_tr_b16 a[28:29], v6 offset:51200
    ds_read_b64_tr_b16 a[30:31], v6 offset:52224
    s_mov_b32 vcc_lo, 0xff00ff00
    s_mov_b32 vcc_hi, 0xff00ff00
    buffer_store_dwordx4 v[168:171], v14, s[24:27], s32 offen sc1
    v_cndmask_b32_dpp v176, v160, v176, vcc row_ror:8 row_mask:0xf bank_mask:0xf
    s_waitcnt lgkmcnt(8)
    v_mfma_f32_32x32x16_bf16 v[112:127], a[8:11], v[32:35], v[112:127]
    s_and_b32 s31, s36, 0xc000
    v_add_u32 v8, s31, v6
    ds_read_b64_tr_b16 a[0:1], v8 offset:53248
    ds_read_b64_tr_b16 a[2:3], v8 offset:54272
    v_cndmask_b32_dpp v177, v161, v177, vcc row_ror:8 row_mask:0xf bank_mask:0xf
    buffer_store_dwordx4 v[172:175], v14, s[24:27], s34 offen sc1
    v_cndmask_b32_dpp v178, v162, v178, vcc row_ror:8 row_mask:0xf bank_mask:0xf
    v_mfma_f32_32x32x16_bf16 v[112:127], a[12:15], v[36:39], v[112:127]
    ds_read_b64_tr_b16 a[4:5], v8 offset:55296
    ds_read_b64_tr_b16 a[6:7], v8 offset:56320
    v_cndmask_b32_dpp v179, v163, v179, vcc row_ror:8 row_mask:0xf bank_mask:0xf
    v_cndmask_b32_dpp v180, v164, v180, vcc row_ror:8 row_mask:0xf bank_mask:0xf
    v_cndmask_b32_dpp v181, v165, v181, vcc row_ror:8 row_mask:0xf bank_mask:0xf
    v_cndmask_b32_dpp v182, v166, v182, vcc row_ror:8 row_mask:0xf bank_mask:0xf
    s_waitcnt lgkmcnt(8)
    v_mfma_f32_32x32x16_bf16 v[112:127], a[16:19], v[40:43], v[112:127]
    s_and_b32 s31, s37, 0xc000
    v_add_u32 v8, s31, v6
    ds_read_b64_tr_b16 a[8:9], v8 offset:57344
    ds_read_b64_tr_b16 a[10:11], v8 offset:58368
L_pad42:
    s_cbranch_execz L_pad43
    v_cndmask_b32_dpp v183, v167, v183, vcc row_ror:8 row_mask:0xf bank_mask:0xf
    buffer_store_dwordx4 v[176:179], v14, s[24:27], s33 offen sc1
    v_mfma_f32_32x32x16_bf16 v[112:127], a[20:23], v[44:47], v[112:127]
    ds_read_b64_tr_b16 a[12:13], v8 offset:59392
    ds_read_b64_tr_b16 a[14:15], v8 offset:60416
    buffer_store_dwordx4 v[180:183], v14, s[24:27], s35 offen sc1
    s_add_u32 s24, s40, s49
    s_addc_u32 s25, s41, 0
    v_mul_f32 v96, v96, v194
    s_waitcnt lgkmcnt(8)
    v_mfma_f32_32x32x16_bf16 v[112:127], a[24:27], v[48:51], v[112:127]
    s_and_b32 s31, s38, 0xc000
    v_add_u32 v8, s31, v6
    ds_read_b64_tr_b16 a[16:17], v8 offset:61440
    ds_read_b64_tr_b16 a[18:19], v8 offset:62464
    v_mul_f32 v97, v97, v194
    v_mul_f32 v98, v98, v194
    v_mul_f32 v99, v99, v194
    v_cvt_pk_bf16_f32 v96, v96, v97
    v_mfma_f32_32x32x16_bf16 v[112:127], a[28:31], v[52:55], v[112:127]
    ds_read_b64_tr_b16 a[20:21], v8 offset:63488
    ds_read_b64_tr_b16 a[22:23], v8 offset:64512
    v_mul_f32 v100, v100, v194
    v_mul_f32 v101, v101, v194
    v_cvt_pk_bf16_f32 v97, v98, v99
    v_mul_f32 v102, v102, v194
    s_waitcnt lgkmcnt(8)
    v_mfma_f32_32x32x16_bf16 v[112:127], a[0:3], v[56:59], v[112:127]
    v_add_u32 v8, 114688, v6
    ds_read_b64_tr_b16 a[24:25], v8
    ds_read_b64_tr_b16 a[26:27], v8 offset:1024
    v_mul_f32 v103, v103, v194
    v_cvt_pk_bf16_f32 v98, v100, v101
    v_mul_f32 v104, v104, v194
    v_mul_f32 v105, v105, v194
    v_mfma_f32_32x32x16_bf16 v[112:127], a[4:7], v[60:63], v[112:127]
    ds_read_b64_tr_b16 a[28:29], v8 offset:2048
    ds_read_b64_tr_b16 a[30:31], v8 offset:3072
    v_cvt_pk_bf16_f32 v99, v102, v103
L_pad43:
    s_cbranch_execz L_pad44
    v_mul_f32 v106, v106, v194
    v_mul_f32 v107, v107, v194
    v_cvt_pk_bf16_f32 v100, v104, v105
    s_waitcnt lgkmcnt(8)
    v_mfma_f32_32x32x16_bf16 v[112:127], a[8:11], v[64:67], v[112:127]
    v_mul_f32 v108, v108, v194
    v_mul_f32 v109, v109, v194
    v_cvt_pk_bf16_f32 v101, v106, v107
    v_mul_f32 v110, v110, v194
    v_mfma_f32_32x32x16_bf16 v[112:127], a[12:15], v[68:71], v[112:127]
    v_mul_f32 v111, v111, v194
    v_cvt_pk_bf16_f32 v102, v108, v109
    v_cvt_pk_bf16_f32 v103, v110, v111
    s_waitcnt lgkmcnt(4)
    v_mfma_f32_32x32x16_bf16 v[112:127], a[16:19], v[72:75], v[112:127]
    v_permlane16_swap_b32 v96, v100
    v_permlane16_swap_b32 v97, v101
    v_mfma_f32_32x32x16_bf16 v[112:127], a[20:23], v[76:79], v[112:127]
    s_waitcnt lgkmcnt(0)
    s_barrier
    v_add_u32 v9, 65536, v5
    ds_read_b64_tr_b16 a[0:1], v9
    ds_read_b64_tr_b16 a[2:3], v9 offset:1024
    ds_read_b64_tr_b16 a[4:5], v9 offset:2048
    ds_read_b64_tr_b16 a[6:7], v9 offset:3072
    v_permlane16_swap_b32 v98, v102
    v_permlane16_swap_b32 v99, v103
    v_mfma_f32_32x32x16_bf16 v[112:127], a[24:27], v[80:83], v[112:127]
    ds_read_b64_tr_b16 a[8:9], v9 offset:4096
    ds_read_b64_tr_b16 a[10:11], v9 offset:5120
    ds_read_b64_tr_b16 a[12:13], v9 offset:6144
    ds_read_b64_tr_b16 a[14:15], v9 offset:7168
    v_mfma_f32_32x32x16_bf16 v[112:127], a[28:31], v[84:87], v[112:127]
    ds_read_b64_tr_b16 a[16:17], v9 offset:8192
    ds_read_b64_tr_b16 a[18:19], v9 offset:9216
    ds_read_b64_tr_b16 a[20:21], v9 offset:10240
    ds_read_b64_tr_b16 a[22:23], v9 offset:11264
    s_waitcnt lgkmcnt(8)
    v_mfma_f32_32x32x16_bf16 v[128:143], a[0:3], v[16:19], 0
L_pad44:
    s_cbranch_execz L_hopdone
    ds_read_b64_tr_b16 a[24:25], v9 offset:12288
    ds_read_b64_tr_b16 a[26:27], v9 offset:13312
    v_mfma_f32_32x32x16_bf16 v[128:143], a[4:7], v[20:23], v[128:143]
    ds_read_b64_tr_b16 a[28:29], v9 offset:14336
    ds_read_b64_tr_b16 a[30:31], v9 offset:15360
    s_waitcnt lgkmcnt(8)
    v_mfma_f32_32x32x16_bf16 v[128:143], a[8:11], v[24:27], v[128:143]
    ds_read_b64_tr_b16 a[0:1], v9 offset:16384
    ds_read_b64_tr_b16 a[2:3], v9 offset:17408
    v_mul_f32 v112, v112, v194
    v_mul_f32 v113, v113, v194
    v_mul_f32 v114, v114, v194
    v_mul_f32 v115, v115, v194
    v_cvt_pk_bf16_f32 v112, v112, v113
    v_mul_f32 v116, v116, v194
    v_mul_f32 v117, v117, v194
    v_cvt_pk_bf16_f32 v113, v114, v115
    v_mfma_f32_32x32x16_bf16 v[128:143], a[12:15], v[28:31], v[128:143]
    ds_read_b64_tr_b16 a[4:5], v9 offset:18432
    ds_read_b64_tr_b16 a[6:7], v9 offset:19456
    v_mul_f32 v118, v118, v194
    v_mul_f32 v119, v119, v194
    v_cvt_pk_bf16_f32 v114, v116, v117
    v_mul_f32 v120, v120, v194
    s_waitcnt lgkmcnt(8)
    v_mfma_f32_32x32x16_bf16 v[128:143], a[16:19], v[32:35], v[128:143]
    s_and_b32 s31, s36, 0x8000
    v_add_u32 v7, s31, v9
    ds_read_b64_tr_b16 a[8:9], v7 offset:20480
    ds_read_b64_tr_b16 a[10:11], v7 offset:21504
    v_mul_f32 v121, v121, v194
    v_cvt_pk_bf16_f32 v115, v118, v119
    v_mul_f32 v122, v122, v194
    v_mul_f32 v123, v123, v194
    v_mfma_f32_32x32x16_bf16 v[128:143], a[20:23], v[36:39], v[128:143]
    ds_read_b64_tr_b16 a[12:13], v7 offset:22528
    ds_read_b64_tr_b16 a[14:15], v7 offset:23552
    v_cvt_pk_bf16_f32 v116, v120, v121
    v_mul_f32 v124, v124, v194
    v_mul_f32 v125, v125, v194
L_pad45:
    s_cbranch_execz L_pad46
    v_cvt_pk_bf16_f32 v117, v122, v123
    s_waitcnt lgkmcnt(8)
    v_mfma_f32_32x32x16_bf16 v[128:143], a[24:27], v[40:43], v[128:143]
    s_and_b32 s31, s37, 0x8000
    v_add_u32 v7, s31, v9
    ds_read_b64_tr_b16 a[16:17], v7 offset:24576
    ds_read_b64_tr_b16 a[18:19], v7 offset:25600
    v_mul_f32 v126, v126, v194
    v_mul_f32 v127, v127, v194
    v_cvt_pk_bf16_f32 v118, v124, v125
    v_cvt_pk_bf16_f32 v119, v126, v127
    v_mfma_f32_32x32x16_bf16 v[128:143], a[28:31], v[44:47], v[128:143]
    ds_read_b64_tr_b16 a[20:21], v7 offset:26624
    ds_read_b64_tr_b16 a[22:23], v7 offset:27648
    v_permlane16_swap_b32 v112, v116
    v_permlane16_swap_b32 v113, v117
    s_waitcnt lgkmcnt(8)
    v_mfma_f32_32x32x16_bf16 v[128:143], a[0:3], v[48:51], v[128:143]
    s_and_b32 s31, s38, 0x8000
    v_add_u32 v7, s31, v9
    ds_read_b64_tr_b16 a[24:25], v7 offset:28672
    ds_read_b64_tr_b16 a[26:27], v7 offset:29696
    v_permlane16_swap_b32 v114, v118
    v_permlane16_swap_b32 v115, v119
    v_mfma_f32_32x32x16_bf16 v[128:143], a[4:7], v[52:55], v[128:143]
    ds_read_b64_tr_b16 a[28:29], v7 offset:30720
    ds_read_b64_tr_b16 a[30:31], v7 offset:31744
    s_mov_b32 vcc_lo, 0x00ff00ff
    s_mov_b32 vcc_hi, 0x00ff00ff
    v_cndmask_b32_dpp v104, v112, v96, vcc row_ror:8 row_mask:0xf bank_mask:0xf
    v_cndmask_b32_dpp v105, v113, v97, vcc row_ror:8 row_mask:0xf bank_mask:0xf
    s_waitcnt lgkmcnt(8)
    v_mfma_f32_32x32x16_bf16 v[128:143], a[8:11], v[56:59], v[128:143]
    v_add_u32 v7, 131072, v5
    ds_read_b64_tr_b16 a[0:1], v7
    ds_read_b64_tr_b16 a[2:3], v7 offset:1024
    v_cndmask_b32_dpp v106, v114, v98, vcc row_ror:8 row_mask:0xf bank_mask:0xf
L_pad46:
    s_cbranch_execz L_pad47
    v_cndmask_b32_dpp v107, v115, v99, vcc row_ror:8 row_mask:0xf bank_mask:0xf
    v_cndmask_b32_dpp v108, v116, v100, vcc row_ror:8 row_mask:0xf bank_mask:0xf
    v_cndmask_b32_dpp v109, v117, v101, vcc row_ror:8 row_mask:0xf bank_mask:0xf
    v_mfma_f32_32x32x16_bf16 v[128:143], a[12:15], v[60:63], v[128:143]
    ds_read_b64_tr_b16 a[4:5], v7 offset:2048
    ds_read_b64_tr_b16 a[6:7], v7 offset:3072
    v_cndmask_b32_dpp v110, v118, v102, vcc row_ror:8 row_mask:0xf bank_mask:0xf
    v_cndmask_b32_dpp v111, v119, v103, vcc row_ror:8 row_mask:0xf bank_mask:0xf
    s_mov_b32 vcc_lo, 0xff00ff00
    s_mov_b32 vcc_hi, 0xff00ff00
    s_waitcnt lgkmcnt(8)
    v_mfma_f32_32x32x16_bf16 v[128:143], a[16:19], v[64:67], v[128:143]
    v_add_u32 v10, 65536, v6
    ds_read_b64_tr_b16 a[8:9], v10
    ds_read_b64_tr_b16 a[10:11], v10 offset:1024
    buffer_store_dwordx4 v[104:107], v14, s[24:27], s32 offen sc1
    v_cndmask_b32_dpp v112, v96, v112, vcc row_ror:8 row_mask:0xf bank_mask:0xf
    v_cndmask_b32_dpp v113, v97, v113, vcc row_ror:8 row_mask:0xf bank_mask:0xf
    v_mfma_f32_32x32x16_bf16 v[128:143], a[20:23], v[68:71], v[128:143]
    ds_read_b64_tr_b16 a[12:13], v10 offset:2048
    ds_read_b64_tr_b16 a[14:15], v10 offset:3072
    buffer_store_dwordx4 v[108:111], v14, s[24:27], s34 offen sc1
    v_cndmask_b32_dpp v114, v98, v114, vcc row_ror:8 row_mask:0xf bank_mask:0xf
    v_cndmask_b32_dpp v115, v99, v115, vcc row_ror:8 row_mask:0xf bank_mask:0xf
    s_waitcnt lgkmcnt(8)
    v_mfma_f32_32x32x16_bf16 v[128:143], a[24:27], v[72:75], v[128:143]
    ds_read_b64_tr_b16 a[16:17], v10 offset:4096
    ds_read_b64_tr_b16 a[18:19], v10 offset:5120
    v_cndmask_b32_dpp v116, v100, v116, vcc row_ror:8 row_mask:0xf bank_mask:0xf
    v_cndmask_b32_dpp v117, v101, v117, vcc row_ror:8 row_mask:0xf bank_mask:0xf
    v_cndmask_b32_dpp v118, v102, v118, vcc row_ror:8 row_mask:0xf bank_mask:0xf
    v_cndmask_b32_dpp v119, v103, v119, vcc row_ror:8 row_mask:0xf bank_mask:0xf
    v_mfma_f32_32x32x16_bf16 v[128:143], a[28:31], v[76:79], v[128:143]
L_pad47:
    s_cbranch_execz L_pad48
    ds_read_b64_tr_b16 a[20:21], v10 offset:6144
    ds_read_b64_tr_b16 a[22:23], v10 offset:7168
    buffer_store_dwordx4 v[112:115], v14, s[24:27], s33 offen sc1
    buffer_store_dwordx4 v[116:119], v14, s[24:27], s35 offen sc1
    s_waitcnt lgkmcnt(8)
    v_mfma_f32_32x32x16_bf16 v[128:143], a[0:3], v[80:83], v[128:143]
    ds_read_b64_tr_b16 a[24:25], v10 offset:8192
    ds_read_b64_tr_b16 a[26:27], v10 offset:9216
    v_mfma_f32_32x32x16_bf16 v[128:143], a[4:7], v[84:87], v[128:143]
    ds_read_b64_tr_b16 a[28:29], v10 offset:10240
    ds_read_b64_tr_b16 a[30:31], v10 offset:11264
    s_waitcnt lgkmcnt(8)
    v_mfma_f32_32x32x16_bf16 v[144:159], a[8:11], v[16:19], 0
    ds_read_b64_tr_b16 a[0:1], v10 offset:12288
    ds_read_b64_tr_b16 a[2:3], v10 offset:13312
    v_mfma_f32_32x32x16_bf16 v[144:159], a[12:15], v[20:23], v[144:159]
    ds_read_b64_tr_b16 a[4:5], v10 offset:14336
    ds_read_b64_tr_b16 a[6:7], v10 offset:15360
    s_waitcnt lgkmcnt(8)
    v_mfma_f32_32x32x16_bf16 v[144:159], a[16:19], v[24:27], v[144:159]
    ds_read_b64_tr_b16 a[8:9], v10 offset:16384
    ds_read_b64_tr_b16 a[10:11], v10 offset:17408
    s_add_u32 s24, s40, s50
    s_addc_u32 s25, s41, 0
    v_mul_f32 v128, v128, v194
    v_mul_f32 v129, v129, v194
    v_mul_f32 v130, v130, v194
    v_mul_f32 v131, v131, v194
    v_cvt_pk_bf16_f32 v128, v128, v129
    v_mul_f32 v132, v132, v194
    v_mfma_f32_32x32x16_bf16 v[144:159], a[20:23], v[28:31], v[144:159]
    ds_read_b64_tr_b16 a[12:13], v10 offset:18432
    ds_read_b64_tr_b16 a[14:15], v10 offset:19456
    v_mul_f32 v133, v133, v194
    v_cvt_pk_bf16_f32 v129, v130, v131
    v_mul_f32 v134, v134, v194
    v_mul_f32 v135, v135, v194
    s_waitcnt lgkmcnt(8)
    v_mfma_f32_32x32x16_bf16 v[144:159], a[24:27], v[32:35], v[144:159]
L_pad48:
    s_cbranch_execz L_pad49
    s_and_b32 s31, s36, 0x8000
    v_add_u32 v8, s31, v10
    ds_read_b64_tr_b16 a[16:17], v8 offset:20480
    ds_read_b64_tr_b16 a[18:19], v8 offset:21504
    v_cvt_pk_bf16_f32 v130, v132, v133
    v_mul_f32 v136, v136, v194
    v_mul_f32 v137, v137, v194
    v_cvt_pk_bf16_f32 v131, v134, v135
    v_mfma_f32_32x32x16_bf16 v[144:159], a[28:31], v[36:39], v[144:159]
    ds_read_b64_tr_b16 a[20:21], v8 offset:22528
    ds_read_b64_tr_b16 a[22:23], v8 offset:23552
    v_mul_f32 v138, v138, v194
    v_mul_f32 v139, v139, v194
    v_cvt_pk_bf16_f32 v132, v136, v137
    v_mul_f32 v140, v140, v194
    s_waitcnt lgkmcnt(8)
    v_mfma_f32_32x32x16_bf16 v[144:159], a[0:3], v[40:43], v[144:159]
    s_and_b32 s31, s37, 0x8000
    v_add_u32 v8, s31, v10
    ds_read_b64_tr_b16 a[24:25], v8 offset:24576
    ds_read_b64_tr_b16 a[26:27], v8 offset:25600
    v_mul_f32 v141, v141, v194
    v_cvt_pk_bf16_f32 v133, v138, v139
    v_mul_f32 v142, v142, v194
    v_mul_f32 v143, v143, v194
    v_mfma_f32_32x32x16_bf16 v[144:159], a[4:7], v[44:47], v[144:159]
    ds_read_b64_tr_b16 a[28:29], v8 offset:26624
    ds_read_b64_tr_b16 a[30:31], v8 offset:27648
    v_cvt_pk_bf16_f32 v134, v140, v141
    v_cvt_pk_bf16_f32 v135, v142, v143
    v_permlane16_swap_b32 v128, v132
    s_waitcnt lgkmcnt(8)
    v_mfma_f32_32x32x16_bf16 v[144:159], a[8:11], v[48:51], v[144:159]
    s_and_b32 s31, s38, 0x8000
    v_add_u32 v8, s31, v10
    ds_read_b64_tr_b16 a[0:1], v8 offset:28672
    ds_read_b64_tr_b16 a[2:3], v8 offset:29696
    v_permlane16_swap_b32 v129, v133
    v_permlane16_swap_b32 v130, v134
    v_mfma_f32_32x32x16_bf16 v[144:159], a[12:15], v[52:55], v[144:159]
L_pad49:
    s_cbranch_execz L_pad50
    ds_read_b64_tr_b16 a[4:5], v8 offset:30720
    ds_read_b64_tr_b16 a[6:7], v8 offset:31744
    v_permlane16_swap_b32 v131, v135
    s_waitcnt lgkmcnt(8)
    v_mfma_f32_32x32x16_bf16 v[144:159], a[16:19], v[56:59], v[144:159]
    v_add_u32 v8, 131072, v6
    ds_read_b64_tr_b16 a[8:9], v8
    ds_read_b64_tr_b16 a[10:11], v8 offset:1024
    v_mfma_f32_32x32x16_bf16 v[144:159], a[20:23], v[60:63], v[144:159]
    ds_read_b64_tr_b16 a[12:13], v8 offset:2048
    ds_read_b64_tr_b16 a[14:15], v8 offset:3072
    s_waitcnt lgkmcnt(8)
    v_mfma_f32_32x32x16_bf16 v[144:159], a[24:27], v[64:67], v[144:159]
    v_mfma_f32_32x32x16_bf16 v[144:159], a[28:31], v[68:71], v[144:159]
    s_waitcnt lgkmcnt(4)
    v_mfma_f32_32x32x16_bf16 v[144:159], a[0:3], v[72:75], v[144:159]
    v_mfma_f32_32x32x16_bf16 v[144:159], a[4:7], v[76:79], v[144:159]
    s_waitcnt lgkmcnt(0)
    s_barrier
    ds_read_b64_tr_b16 a[16:17], v5
    ds_read_b64_tr_b16 a[18:19], v5 offset:1024
    ds_read_b64_tr_b16 a[20:21], v5 offset:2048
    ds_read_b64_tr_b16 a[22:23], v5 offset:3072
    v_mfma_f32_32x32x16_bf16 v[144:159], a[8:11], v[80:83], v[144:159]
    ds_read_b64_tr_b16 a[24:25], v5 offset:4096
    ds_read_b64_tr_b16 a[26:27], v5 offset:5120
    ds_read_b64_tr_b16 a[28:29], v5 offset:6144
    ds_read_b64_tr_b16 a[30:31], v5 offset:7168
    v_mfma_f32_32x32x16_bf16 v[144:159], a[12:15], v[84:87], v[144:159]
    ds_read_b64_tr_b16 a[0:1], v5 offset:8192
    ds_read_b64_tr_b16 a[2:3], v5 offset:9216
    ds_read_b64_tr_b16 a[4:5], v5 offset:10240
    ds_read_b64_tr_b16 a[6:7], v5 offset:11264
    s_waitcnt lgkmcnt(8)
    v_mfma_f32_32x32x16_bf16 v[160:175], a[16:19], v[16:19], 0
L_pad50:
    s_cbranch_execz L_pad51
    ds_read_b64_tr_b16 a[8:9], v5 offset:12288
    ds_read_b64_tr_b16 a[10:11], v5 offset:13312
    v_mfma_f32_32x32x16_bf16 v[160:175], a[20:23], v[20:23], v[160:175]
    ds_read_b64_tr_b16 a[12:13], v5 offset:14336
    ds_read_b64_tr_b16 a[14:15], v5 offset:15360
    s_waitcnt lgkmcnt(8)
    v_mfma_f32_32x32x16_bf16 v[160:175], a[24:27], v[24:27], v[160:175]
    ds_read_b64_tr_b16 a[16:17], v5 offset:16384
    ds_read_b64_tr_b16 a[18:19], v5 offset:17408
    v_mul_f32 v144, v144, v194
    v_mul_f32 v145, v145, v194
    v_mul_f32 v146, v146, v194
    v_mul_f32 v147, v147, v194
    v_cvt_pk_bf16_f32 v144, v144, v145
    v_mul_f32 v148, v148, v194
    v_mul_f32 v149, v149, v194
    v_cvt_pk_bf16_f32 v145, v146, v147
    v_mfma_f32_32x32x16_bf16 v[160:175], a[28:31], v[28:31], v[160:175]
    ds_read_b64_tr_b16 a[20:21], v5 offset:18432
    ds_read_b64_tr_b16 a[22:23], v5 offset:19456
    v_mul_f32 v150, v150, v194
    v_mul_f32 v151, v151, v194
    v_cvt_pk_bf16_f32 v146, v148, v149
    v_mul_f32 v152, v152, v194
    s_waitcnt lgkmcnt(8)
    v_mfma_f32_32x32x16_bf16 v[160:175], a[0:3], v[32:35], v[160:175]
    s_and_b32 s31, s36, 0x1c000
    v_add_u32 v7, s31, v5
    ds_read_b64_tr_b16 a[24:25], v7 offset:20480
    ds_read_b64_tr_b16 a[26:27], v7 offset:21504
    v_mul_f32 v153, v153, v194
    v_cvt_pk_bf16_f32 v147, v150, v151
    v_mul_f32 v154, v154, v194
    v_mul_f32 v155, v155, v194
    v_mfma_f32_32x32x16_bf16 v[160:175], a[4:7], v[36:39], v[160:175]
    ds_read_b64_tr_b16 a[28:29], v7 offset:22528
    ds_read_b64_tr_b16 a[30:31], v7 offset:23552
    v_cvt_pk_bf16_f32 v148, v152, v153
    v_mul_f32 v156, v156, v194
    v_mul_f32 v157, v157, v194
L_pad51:
    s_cbranch_execz L_pad52
    v_cvt_pk_bf16_f32 v149, v154, v155
    s_waitcnt lgkmcnt(8)
    v_mfma_f32_32x32x16_bf16 v[160:175], a[8:11], v[40:43], v[160:175]
    s_and_b32 s31, s37, 0x1c000
    v_add_u32 v7, s31, v5
    ds_read_b64_tr_b16 a[0:1], v7 offset:24576
    ds_read_b64_tr_b16 a[2:3], v7 offset:25600
    v_mul_f32 v158, v158, v194
    v_mul_f32 v159, v159, v194
    v_cvt_pk_bf16_f32 v150, v156, v157
    v_cvt_pk_bf16_f32 v151, v158, v159
    v_mfma_f32_32x32x16_bf16 v[160:175], a[12:15], v[44:47], v[160:175]
    ds_read_b64_tr_b16 a[4:5], v7 offset:26624
    ds_read_b64_tr_b16 a[6:7], v7 offset:27648
    v_permlane16_swap_b32 v144, v148
    v_permlane16_swap_b32 v145, v149
    s_waitcnt lgkmcnt(8)
    v_mfma_f32_32x32x16_bf16 v[160:175], a[16:19], v[48:51], v[160:175]
    s_and_b32 s31, s38, 0x1c000
    v_add_u32 v7, s31, v5
    ds_read_b64_tr_b16 a[8:9], v7 offset:28672
    ds_read_b64_tr_b16 a[10:11], v7 offset:29696
    v_permlane16_swap_b32 v146, v150
    v_permlane16_swap_b32 v147, v151
    v_mfma_f32_32x32x16_bf16 v[160:175], a[20:23], v[52:55], v[160:175]
    ds_read_b64_tr_b16 a[12:13], v7 offset:30720
    ds_read_b64_tr_b16 a[14:15], v7 offset:31744
    s_mov_b32 vcc_lo, 0x00ff00ff
    s_mov_b32 vcc_hi, 0x00ff00ff
    v_cndmask_b32_dpp v136, v144, v128, vcc row_ror:8 row_mask:0xf bank_mask:0xf
    v_cndmask_b32_dpp v137, v145, v129, vcc row_ror:8 row_mask:0xf bank_mask:0xf
    s_waitcnt lgkmcnt(8)
    v_mfma_f32_32x32x16_bf16 v[160:175], a[24:27], v[56:59], v[160:175]
    v_add_u32 v7, 147456, v5
    ds_read_b64_tr_b16 a[16:17], v7
    ds_read_b64_tr_b16 a[18:19], v7 offset:1024
    v_cndmask_b32_dpp v138, v146, v130, vcc row_ror:8 row_mask:0xf bank_mask:0xf
L_pad52:
    s_cbranch_execz L_pad53
    v_cndmask_b32_dpp v139, v147, v131, vcc row_ror:8 row_mask:0xf bank_mask:0xf
    v_cndmask_b32_dpp v140, v148, v132, vcc row_ror:8 row_mask:0xf bank_mask:0xf
    v_cndmask_b32_dpp v141, v149, v133, vcc row_ror:8 row_mask:0xf bank_mask:0xf
    v_mfma_f32_32x32x16_bf16 v[160:175], a[28:31], v[60:63], v[160:175]
    ds_read_b64_tr_b16 a[20:21], v7 offset:2048
    ds_read_b64_tr_b16 a[22:23], v7 offset:3072
    v_cndmask_b32_dpp v142, v150, v134, vcc row_ror:8 row_mask:0xf bank_mask:0xf
    v_cndmask_b32_dpp v143, v151, v135, vcc row_ror:8 row_mask:0xf bank_mask:0xf
    s_mov_b32 vcc_lo, 0xff00ff00
    s_mov_b32 vcc_hi, 0xff00ff00
    s_waitcnt lgkmcnt(8)
    v_mfma_f32_32x32x16_bf16 v[160:175], a[0:3], v[64:67], v[160:175]
    ds_read_b64_tr_b16 a[24:25], v6
    ds_read_b64_tr_b16 a[26:27], v6 offset:1024
    buffer_store_dwordx4 v[136:139], v14, s[24:27], s32 offen sc1
    v_cndmask_b32_dpp v144, v128, v144, vcc row_ror:8 row_mask:0xf bank_mask:0xf
    v_cndmask_b32_dpp v145, v129, v145, vcc row_ror:8 row_mask:0xf bank_mask:0xf
    v_mfma_f32_32x32x16_bf16 v[160:175], a[4:7], v[68:71], v[160:175]
    ds_read_b64_tr_b16 a[28:29], v6 offset:2048
    ds_read_b64_tr_b16 a[30:31], v6 offset:3072
    buffer_store_dwordx4 v[140:143], v14, s[24:27], s34 offen sc1
    v_cndmask_b32_dpp v146, v130, v146, vcc row_ror:8 row_mask:0xf bank_mask:0xf
    v_cndmask_b32_dpp v147, v131, v147, vcc row_ror:8 row_mask:0xf bank_mask:0xf
    s_waitcnt lgkmcnt(8)
    v_mfma_f32_32x32x16_bf16 v[160:175], a[8:11], v[72:75], v[160:175]
    ds_read_b64_tr_b16 a[0:1], v6 offset:4096
    ds_read_b64_tr_b16 a[2:3], v6 offset:5120
    v_cndmask_b32_dpp v148, v132, v148, vcc row_ror:8 row_mask:0xf bank_mask:0xf
    v_cndmask_b32_dpp v149, v133, v149, vcc row_ror:8 row_mask:0xf bank_mask:0xf
    v_cndmask_b32_dpp v150, v134, v150, vcc row_ror:8 row_mask:0xf bank_mask:0xf
    v_cndmask_b32_dpp v151, v135, v151, vcc row_ror:8 row_mask:0xf bank_mask:0xf
    v_mfma_f32_32x32x16_bf16 v[160:175], a[12:15], v[76:79], v[160:175]
    ds_read_b64_tr_b16 a[4:5], v6 offset:6144
L_pad53:
    s_cbranch_execz L_pad54
    ds_read_b64_tr_b16 a[6:7], v6 offset:7168
    buffer_store_dwordx4 v[144:147], v14, s[24:27], s33 offen sc1
    buffer_store_dwordx4 v[148:151], v14, s[24:27], s35 offen sc1
    s_waitcnt lgkmcnt(8)
    v_mfma_f32_32x32x16_bf16 v[160:175], a[16:19], v[80:83], v[160:175]
    ds_read_b64_tr_b16 a[8:9], v6 offset:8192
    ds_read_b64_tr_b16 a[10:11], v6 offset:9216
    v_mfma_f32_32x32x16_bf16 v[160:175], a[20:23], v[84:87], v[160:175]
    ds_read_b64_tr_b16 a[12:13], v6 offset:10240
    ds_read_b64_tr_b16 a[14:15], v6 offset:11264
    s_waitcnt lgkmcnt(8)
    v_mfma_f32_32x32x16_bf16 v[176:191], a[24:27], v[16:19], 0
    ds_read_b64_tr_b16 a[16:17], v6 offset:12288
    ds_read_b64_tr_b16 a[18:19], v6 offset:13312
    v_mfma_f32_32x32x16_bf16 v[176:191], a[28:31], v[20:23], v[176:191]
    ds_read_b64_tr_b16 a[20:21], v6 offset:14336
    ds_read_b64_tr_b16 a[22:23], v6 offset:15360
    s_waitcnt lgkmcnt(8)
    v_mfma_f32_32x32x16_bf16 v[176:191], a[0:3], v[24:27], v[176:191]
    ds_read_b64_tr_b16 a[24:25], v6 offset:16384
    ds_read_b64_tr_b16 a[26:27], v6 offset:17408
    s_add_u32 s24, s40, s51
    s_addc_u32 s25, s41, 0
    v_mul_f32 v160, v160, v194
    v_mul_f32 v161, v161, v194
    v_mul_f32 v162, v162, v194
    v_mul_f32 v163, v163, v194
    v_cvt_pk_bf16_f32 v160, v160, v161
    v_mul_f32 v164, v164, v194
    v_mfma_f32_32x32x16_bf16 v[176:191], a[4:7], v[28:31], v[176:191]
    ds_read_b64_tr_b16 a[28:29], v6 offset:18432
    ds_read_b64_tr_b16 a[30:31], v6 offset:19456
    v_mul_f32 v165, v165, v194
    v_cvt_pk_bf16_f32 v161, v162, v163
    v_mul_f32 v166, v166, v194
    v_mul_f32 v167, v167, v194
    s_waitcnt lgkmcnt(8)
    v_mfma_f32_32x32x16_bf16 v[176:191], a[8:11], v[32:35], v[176:191]
    s_and_b32 s31, s36, 0x1c000
L_pad54:
    s_cbranch_execz L_pad55
    v_add_u32 v8, s31, v6
    ds_read_b64_tr_b16 a[0:1], v8 offset:20480
    ds_read_b64_tr_b16 a[2:3], v8 offset:21504
    v_cvt_pk_bf16_f32 v162, v164, v165
    v_mul_f32 v168, v168, v194
    v_mul_f32 v169, v169, v194
    v_cvt_pk_bf16_f32 v163, v166, v167
    v_mfma_f32_32x32x16_bf16 v[176:191], a[12:15], v[36:39], v[176:191]
    ds_read_b64_tr_b16 a[4:5], v8 offset:22528
    ds_read_b64_tr_b16 a[6:7], v8 offset:23552
    v_mul_f32 v170, v170, v194
    v_mul_f32 v171, v171, v194
    v_cvt_pk_bf16_f32 v164, v168, v169
    v_mul_f32 v172, v172, v194
    s_waitcnt lgkmcnt(8)
    v_mfma_f32_32x32x16_bf16 v[176:191], a[16:19], v[40:43], v[176:191]
    s_and_b32 s31, s37, 0x1c000
    v_add_u32 v8, s31, v6
    ds_read_b64_tr_b16 a[8:9], v8 offset:24576
    ds_read_b64_tr_b16 a[10:11], v8 offset:25600
    v_mul_f32 v173, v173, v194
    v_cvt_pk_bf16_f32 v165, v170, v171
    v_mul_f32 v174, v174, v194
    v_mul_f32 v175, v175, v194
    v_mfma_f32_32x32x16_bf16 v[176:191], a[20:23], v[44:47], v[176:191]
    ds_read_b64_tr_b16 a[12:13], v8 offset:26624
    ds_read_b64_tr_b16 a[14:15], v8 offset:27648
    v_cvt_pk_bf16_f32 v166, v172, v173
    v_cvt_pk_bf16_f32 v167, v174, v175
    v_permlane16_swap_b32 v160, v164
    s_waitcnt lgkmcnt(8)
    v_mfma_f32_32x32x16_bf16 v[176:191], a[24:27], v[48:51], v[176:191]
    s_and_b32 s31, s38, 0x1c000
    v_add_u32 v8, s31, v6
    ds_read_b64_tr_b16 a[16:17], v8 offset:28672
    ds_read_b64_tr_b16 a[18:19], v8 offset:29696
    v_permlane16_swap_b32 v161, v165
    v_permlane16_swap_b32 v162, v166
    v_mfma_f32_32x32x16_bf16 v[176:191], a[28:31], v[52:55], v[176:191]
    ds_read_b64_tr_b16 a[20:21], v8 offset:30720
L_pad55:
    s_cbranch_execz L_pad56
    ds_read_b64_tr_b16 a[22:23], v8 offset:31744
    v_permlane16_swap_b32 v163, v167
    s_waitcnt lgkmcnt(8)
    v_mfma_f32_32x32x16_bf16 v[176:191], a[0:3], v[56:59], v[176:191]
    v_add_u32 v8, 147456, v6
    ds_read_b64_tr_b16 a[24:25], v8
    ds_read_b64_tr_b16 a[26:27], v8 offset:1024
    v_mfma_f32_32x32x16_bf16 v[176:191], a[4:7], v[60:63], v[176:191]
    ds_read_b64_tr_b16 a[28:29], v8 offset:2048
    ds_read_b64_tr_b16 a[30:31], v8 offset:3072
    s_waitcnt lgkmcnt(8)
    v_mfma_f32_32x32x16_bf16 v[176:191], a[8:11], v[64:67], v[176:191]
    v_mfma_f32_32x32x16_bf16 v[176:191], a[12:15], v[68:71], v[176:191]
    s_waitcnt lgkmcnt(4)
    v_mfma_f32_32x32x16_bf16 v[176:191], a[16:19], v[72:75], v[176:191]
    v_mfma_f32_32x32x16_bf16 v[176:191], a[20:23], v[76:79], v[176:191]
    s_waitcnt lgkmcnt(0)
    v_mfma_f32_32x32x16_bf16 v[176:191], a[24:27], v[80:83], v[176:191]
    v_mfma_f32_32x32x16_bf16 v[176:191], a[28:31], v[84:87], v[176:191]
    s_nop 11
    v_mul_f32 v176, v176, v194
    v_mul_f32 v177, v177, v194
    v_mul_f32 v178, v178, v194
    v_mul_f32 v179, v179, v194
    v_cvt_pk_bf16_f32 v176, v176, v177
    v_mul_f32 v180, v180, v194
    v_mul_f32 v181, v181, v194
    v_cvt_pk_bf16_f32 v177, v178, v179
    v_mul_f32 v182, v182, v194
    v_mul_f32 v183, v183, v194
    v_cvt_pk_bf16_f32 v178, v180, v181
    v_mul_f32 v184, v184, v194
    v_mul_f32 v185, v185, v194
    v_cvt_pk_bf16_f32 v179, v182, v183
    v_mul_f32 v186, v186, v194
    v_mul_f32 v187, v187, v194
    v_cvt_pk_bf16_f32 v180, v184, v185
    v_mul_f32 v188, v188, v194
    v_mul_f32 v189, v189, v194
    v_cvt_pk_bf16_f32 v181, v186, v187
    v_mul_f32 v190, v190, v194
    v_mul_f32 v191, v191, v194
    v_cvt_pk_bf16_f32 v182, v188, v189
L_pad56:
    s_cbranch_execz L_hopdone
    v_cvt_pk_bf16_f32 v183, v190, v191
    v_permlane16_swap_b32 v176, v180
    v_permlane16_swap_b32 v177, v181
    v_permlane16_swap_b32 v178, v182
    v_permlane16_swap_b32 v179, v183
    s_mov_b32 vcc_lo, 0x00ff00ff
    s_mov_b32 vcc_hi, 0x00ff00ff
    v_cndmask_b32_dpp v168, v176, v160, vcc row_ror:8 row_mask:0xf bank_mask:0xf
    v_cndmask_b32_dpp v169, v177, v161, vcc row_ror:8 row_mask:0xf bank_mask:0xf
    v_cndmask_b32_dpp v170, v178, v162, vcc row_ror:8 row_mask:0xf bank_mask:0xf
    v_cndmask_b32_dpp v171, v179, v163, vcc row_ror:8 row_mask:0xf bank_mask:0xf
    v_cndmask_b32_dpp v172, v180, v164, vcc row_ror:8 row_mask:0xf bank_mask:0xf
    v_cndmask_b32_dpp v173, v181, v165, vcc row_ror:8 row_mask:0xf bank_mask:0xf
    v_cndmask_b32_dpp v174, v182, v166, vcc row_ror:8 row_mask:0xf bank_mask:0xf
    v_cndmask_b32_dpp v175, v183, v167, vcc row_ror:8 row_mask:0xf bank_mask:0xf
    s_mov_b32 vcc_lo, 0xff00ff00
    s_mov_b32 vcc_hi, 0xff00ff00
    buffer_store_dwordx4 v[168:171], v14, s[24:27], s32 offen sc1
    v_cndmask_b32_dpp v176, v160, v176, vcc row_ror:8 row_mask:0xf bank_mask:0xf
    v_cndmask_b32_dpp v177, v161, v177, vcc row_ror:8 row_mask:0xf bank_mask:0xf
    buffer_store_dwordx4 v[172:175], v14, s[24:27], s34 offen sc1
    v_cndmask_b32_dpp v178, v162, v178, vcc row_ror:8 row_mask:0xf bank_mask:0xf
    v_cndmask_b32_dpp v179, v163, v179, vcc row_ror:8 row_mask:0xf bank_mask:0xf
    v_cndmask_b32_dpp v180, v164, v180, vcc row_ror:8 row_mask:0xf bank_mask:0xf
    v_cndmask_b32_dpp v181, v165, v181, vcc row_ror:8 row_mask:0xf bank_mask:0xf
    v_cndmask_b32_dpp v182, v166, v182, vcc row_ror:8 row_mask:0xf bank_mask:0xf
    v_cndmask_b32_dpp v183, v167, v183, vcc row_ror:8 row_mask:0xf bank_mask:0xf
    buffer_store_dwordx4 v[176:179], v14, s[24:27], s33 offen sc1
    buffer_store_dwordx4 v[180:183], v14, s[24:27], s35 offen sc1
    s_endpgm
L_codeend:
.section .rodata,"a"
.p2align 6
.amdhsa_kernel standalone__sliding_window_attn__prompt_kernel
  .amdhsa_next_free_vgpr 256
  .amdhsa_next_free_sgpr 102
  .amdhsa_accum_offset 196
  .amdhsa_group_segment_fixed_size 0
  .amdhsa_kernarg_size 56
  .amdhsa_user_sgpr_count 2
  .amdhsa_user_sgpr_kernarg_segment_ptr 1
  .amdhsa_system_sgpr_workgroup_id_x 1
.end_amdhsa_kernel
```
